```python
import torch

def _softmax(x, axis=-1):
    return torch.softmax(x, dim=axis)
def _gelu(x):
    return torch.nn.functional.gelu(x, approximate="tanh")
def _silu(x):
    return torch.nn.functional.silu(x)
def _sigmoid(x):
    return torch.sigmoid(x)
def _layernorm(x, axis=-1, eps=1e-5):
    m = x.mean(dim=axis, keepdim=True)
    v = x.var(dim=axis, keepdim=True, unbiased=False)
    return (x - m) / torch.sqrt(v + eps)
def _scatter_add(tgt, idx, src, axis=0):
    return tgt.clone().index_add_(axis, idx, src)
def _segment_sum(src, seg, n):
    out = torch.zeros((n,) + src.shape[1:], dtype=src.dtype)
    return out.index_add_(0, seg, src)
def _pad(x, pw):
    flat = tuple(v for pair in reversed(pw) for v in pair)
    return torch.nn.functional.pad(x, flat)

kernel_name = 'interleave_layers__sliding_block_cached__dense_activation_gelu__decode'

def setup_inputs():

    _w = (lambda a: (lambda t: t.to(torch.bfloat16) if t.is_floating_point() else t)(torch.as_tensor(a)))
    def _A_setup():
        B, Sq, D = 4, 1, 576
        Hq, Hkv, Sk, Dh = 32, 16, 8192, 128
        assert Hq % Hkv == 0, (Hq, Hkv)
        return {
            "x": _w((lambda *s: torch.randn(*s, dtype=torch.bfloat16) * 0.05)(B, Sq, D)),
            "k_cache": _w((lambda *s: torch.randn(*s, dtype=torch.bfloat16) * 0.8)(B, Hkv, Sk, Dh)),
            "v_cache": _w((lambda *s: torch.randn(*s, dtype=torch.bfloat16) * 1.6)(B, Hkv, Sk, Dh)),
            "wq": _w((lambda *s: torch.randn(*s, dtype=torch.bfloat16) * 0.8)(D, Hq * Dh) * (D ** -0.5)),
            "wo": _w((lambda *s: torch.randn(*s, dtype=torch.bfloat16) * 1.6)(Hq * Dh, D) * ((Hq * Dh) ** -0.5)),
        }
    _A_in = _A_setup()

    def _B_setup():
        B, S, D, F = 4, 1, 576, 4608
        return {
            "x": _w((lambda *s: torch.randn(*s, dtype=torch.bfloat16) * 0.05)(B, S, D)),
            "w1": _w((lambda *s: torch.randn(*s, dtype=torch.bfloat16) * 0.4)(D, F) * (D ** -0.5)),
            "b1": _w((lambda *s: torch.randn(*s, dtype=torch.bfloat16) * 0.4)(F) * 0.01),
            "w2": _w((lambda *s: torch.randn(*s, dtype=torch.bfloat16) * 0.4)(F, D) * (F ** -0.5)),
            "b2": _w((lambda *s: torch.randn(*s, dtype=torch.bfloat16) * 0.4)(D) * 0.01),
        }
    _B_in = _B_setup()

    return {
        "A_x": _A_in["x"],
        "A_k_cache": _A_in["k_cache"],
        "A_v_cache": _A_in["v_cache"],
        "A_wq": _A_in["wq"],
        "A_wo": _A_in["wo"],
        "B_x": _B_in["x"],
        "B_w1": _B_in["w1"],
        "B_b1": _B_in["b1"],
        "B_w2": _B_in["w2"],
        "B_b2": _B_in["b2"],
    }

def reference(A_x, A_k_cache, A_v_cache, A_wq, A_wo, B_x, B_w1, B_b1, B_w2, B_b2):
    def _A_ref(x, k_cache, v_cache, wq, wo):
        B, Sq, D = x.shape
        Hq, Dh = 32, 128
        Hkv, Sk = k_cache.shape[1], k_cache.shape[2]
        W = min(4096, max(256, Sk // 4))
        rep = Hq // Hkv
        q = (lambda x, *d: x.permute(*d))((x @ wq).reshape(B, Sq, Hq, Dh), 0, 2, 1, 3)
        k = (lambda x, n, axis: torch.repeat_interleave(x, n, dim=axis))(k_cache[:, :, Sk - W:, :], rep, axis=1)
        v = (lambda x, n, axis: torch.repeat_interleave(x, n, dim=axis))(v_cache[:, :, Sk - W:, :], rep, axis=1)
        scores = torch.einsum("bhqd,bhkd->bhqk", q, k) * (Dh ** -0.5)
        p = _softmax(scores, axis=-1)
        o = torch.einsum("bhqk,bhkd->bhqd", p, v)
        return (lambda x, *d: x.permute(*d))(o, 0, 2, 1, 3).reshape(B, Sq, Hq * Dh) @ wo

    def _B_ref(x, w1, b1, w2, b2):
        h = torch.einsum("bsd,df->bsf", x, w1) + b1
        h = _gelu(h)
        return torch.einsum("bsf,fd->bsd", h, w2) + b2

    x = A_x
    x = x + _A_ref(_layernorm(x, axis=-1), A_k_cache, A_v_cache, A_wq, A_wo)
    x = x + _B_ref(_layernorm(x, axis=-1), B_w1, B_b1, B_w2, B_b2)
    x = x + _A_ref(_layernorm(x, axis=-1), A_k_cache, A_v_cache, A_wq, A_wo)
    x = x + _B_ref(_layernorm(x, axis=-1), B_w1, B_b1, B_w2, B_b2)
    return x
```

```asm
; @launch grid=(256,1,1) block=(256,1,1) lds=161792
.amdgcn_target "amdgcn-amd-amdhsa--gfx950"
.text
.globl interleave_layers__sliding_block_cached__dense_activation_gelu__decode_kernel
.p2align 8
.type interleave_layers__sliding_block_cached__dense_activation_gelu__decode_kernel,@function
interleave_layers__sliding_block_cached__dense_activation_gelu__decode_kernel:
    s_cmp_ge_u32 s2, 256
    s_cbranch_scc1 LEND
    s_load_dwordx16 s[4:19], s[0:1], 0
    s_load_dwordx8 s[20:27], s[0:1], 64
    s_load_dwordx2 s[28:29], s[0:1], 96
    v_and_b32 v1, 63, v0
    v_lshrrev_b32 v238, 6, v0
    s_add_u32 s81, s2, 0
    s_and_b32 s81, s81, 7
    v_readfirstlane_b32 s80, v238
    s_lshr_b32 s82, s2, 3
    s_mov_b32 s94, 0x000f000f
    s_mov_b32 s95, 0x000f000f
    v_and_b32 v239, 15, v1
    v_lshrrev_b32 v240, 4, v1
    v_lshlrev_b32 v251, 4, v1
    v_mov_b32 v242, -1
    v_mov_b32 v243, -1
    v_mov_b32 v244, -1
    v_mov_b32 v245, -1
    s_lshr_b32 s100, s82, 3
    s_mul_i32 s3, s100, 160
    s_cmp_eq_u32 s100, 3
    s_cselect_b32 s3, 448, s3
    s_cmp_ge_u32 s100, 2
    s_cselect_b32 s85, 0x40000000, 0
    s_lshl_b32 s98, s3, 1
    v_mul_u32_u24 v248, 1152, v239
    v_add_u32 v248, s98, v248
    v_lshl_add_u32 v248, v240, 4, v248
    v_lshrrev_b32 v241, 3, v1
    v_lshlrev_b32 v249, 13, v241
    v_and_b32 v241, 1, v240
    v_lshlrev_b32 v241, 1, v241
    s_and_b32 s98, s80, 1
    s_lshl_b32 s98, s98, 2
    v_xor_b32 v241, s98, v241
    v_and_b32 v246, 7, v1
    v_xor_b32 v241, v241, v246
    v_lshl_add_u32 v249, v241, 4, v249
    s_and_b32 s98, s82, 7
    s_lshl_b32 s99, s98, 8
    s_lshl_b32 s101, s100, 11
    s_add_u32 s99, s99, s101
    v_lshlrev_b32 v250, 13, v240
    v_lshl_add_u32 v250, v239, 4, v250
    v_add_u32 v250, s99, v250
    s_lshl_b32 s101, s80, 6
    s_add_u32 s99, s99, s101
    v_lshlrev_b32 v6, 13, v239
    v_lshl_add_u32 v6, v240, 4, v6
    v_add_u32 v6, s99, v6
    s_lshl_b32 s99, s98, 7
    s_lshl_b32 s101, s100, 3
    s_add_u32 s99, s99, s101
    s_add_u32 s99, s99, 4
    v_lshl_add_u32 v7, v239, 5, s99
    v_lshlrev_b32 v241, 2, v240
    v_sub_u32 v7, v7, v241
    v_cmp_eq_u32 vcc, 4, v239
    v_mov_b32 v246, 0x3f803f80
    v_mov_b32 v247, 0
    v_cndmask_b32 v154, v247, v246, vcc
    v_xor_b32 v241, v240, v239
    v_lshlrev_b32 v241, 4, v241
    v_lshl_add_u32 v34, v240, 8, v241
    v_xor_b32 v35, 64, v34
    v_xor_b32 v36, 128, v34
    v_xor_b32 v37, 192, v34
    s_lshl_b32 s79, s98, 7
    s_lshl_b32 s99, s81, 10
    s_add_u32 s76, s79, s99
    s_sub_u32 s75, 4718592, s76
    s_mul_i32 s79, s80, 37888
    s_and_b32 s98, s82, 1
    s_lshl_b32 s99, s81, 1
    s_add_u32 s99, s99, s98
    s_lshl_b32 s99, s99, 21
    s_bfe_u32 s100, s82, 0x20001
    s_lshl_b32 s100, s100, 25
    s_add_u32 s99, s99, s100
    s_lshr_b32 s100, s82, 3
    s_lshl_b32 s100, s100, 17
    s_add_u32 s99, s99, s100
    s_add_u32 s101, s99, 1572864
    s_mul_i32 s84, s2, 17
    s_add_u32 s84, s84, s80
    s_and_b32 s84, s84, 127
    s_lshl_b32 s84, s84, 10
    s_mul_i32 s87, s81, 131072
    s_mul_i32 s72, s81, 41984
    s_add_u32 s72, s72, 1572864
    s_add_u32 s73, s72, 40960
    v_mov_b32 v155, v154
    v_mov_b32 v156, v154
    v_mov_b32 v157, v154
    v_mov_b32 v158, v154
    v_mov_b32 v159, v154
    v_mov_b32 v160, v154
    v_mov_b32 v161, v154
    v_mov_b32 v162, v154
    v_mov_b32 v163, v154
    v_mov_b32 v164, v154
    v_mov_b32 v165, v154
    v_mov_b32 v166, v154
    v_mov_b32 v167, v154
    v_mov_b32 v168, v154
    v_mov_b32 v169, v154
    v_mov_b32 v170, v154
    v_mov_b32 v171, v154
    v_mov_b32 v172, v154
    v_mov_b32 v173, v154
    s_waitcnt lgkmcnt(0)
    s_add_u32 s32, s6, s101
    s_addc_u32 s33, s7, 0
    s_mov_b32 s34, 131072
    s_mov_b32 s35, 0x20000
    s_add_u32 m0, s79, 0
    s_nop 0
    buffer_load_dwordx4 v34, s[32:35], s84 offen nt lds
    s_add_u32 s84, s84, 4096
    s_and_b32 s84, s84, 0x1ffff
    s_add_u32 m0, s79, 1024
    s_nop 0
    buffer_load_dwordx4 v35, s[32:35], s84 offen nt lds
    s_add_u32 s84, s84, 4096
    s_and_b32 s84, s84, 0x1ffff
    s_add_u32 m0, s79, 2048
    s_nop 0
    buffer_load_dwordx4 v36, s[32:35], s84 offen nt lds
    s_add_u32 s84, s84, 4096
    s_and_b32 s84, s84, 0x1ffff
    s_add_u32 m0, s79, 3072
    s_nop 0
    buffer_load_dwordx4 v37, s[32:35], s84 offen nt lds
    s_add_u32 s84, s84, 4096
    s_and_b32 s84, s84, 0x1ffff
    s_cmp_lg_u32 s80, 1
    s_cbranch_scc1 Ltc1
    s_add_u32 s52, s8, s101
    s_addc_u32 s53, s9, 0
    s_mov_b32 s54, 131072
    s_mov_b32 s55, 0x20000
    v_lshlrev_b32 v241, 16, v1
    buffer_load_dword v52, v241, s[52:55], 0 offen
    s_mov_b32 s52, s24
    s_mov_b32 s53, s25
    s_mov_b32 s54, 4608
    s_mov_b32 s55, 0x20000
    v_lshlrev_b32 v241, 16, v1
    buffer_load_dword v52, v241, s[52:55], 0 offen
Ltc1:
    s_mov_b32 s48, s28
    s_mov_b32 s49, s29
    s_mov_b32 s50, 1908736
    s_mov_b32 s51, 0x20000
    s_cmp_lg_u32 s80, 0
    s_cbranch_scc1 Lnc2
    s_mul_i32 s98, s2, 6144
    s_add_u32 s99, s98, 4096
    buffer_store_dwordx4 v[242:245], v251, s[48:51], s98 offen offset:0 sc1
    buffer_store_dwordx4 v[242:245], v251, s[48:51], s98 offen offset:1024 sc1
    buffer_store_dwordx4 v[242:245], v251, s[48:51], s98 offen offset:2048 sc1
    buffer_store_dwordx4 v[242:245], v251, s[48:51], s98 offen offset:3072 sc1
    buffer_store_dwordx4 v[242:245], v251, s[48:51], s99 offen sc1
    buffer_store_dwordx4 v[242:245], v251, s[48:51], s99 offen offset:1024 sc1
    buffer_store_dwordx4 v[242:245], v250, s[48:51], s72 offen sc1
    s_add_u32 s98, s72, 32768
    s_mov_b64 exec, 0xffff
    buffer_store_dwordx4 v[242:245], v250, s[48:51], s98 offen sc1
    s_mov_b32 exec_lo, 0x000f000f
    buffer_store_dword v242, v7, s[48:51], s73 offen sc1
    s_mov_b64 exec, -1
Lnc2:
    s_mov_b32 s64, s4
    s_mov_b32 s65, s5
    s_mov_b32 s66, 4608
    s_mov_b32 s67, 0x20000
    s_add_u32 s40, s10, s76
    s_addc_u32 s41, s11, 0
    s_mov_b32 s42, s75
    s_mov_b32 s43, 0x20000
    s_mov_b64 exec, s[94:95]
    buffer_load_dwordx4 v[154:157], v248, s[64:67], 0 offen
    buffer_load_dwordx4 v[158:161], v248, s[64:67], 0 offen offset:64
    buffer_load_dwordx4 v[162:165], v248, s[64:67], 0 offen offset:128
    buffer_load_dwordx4 v[166:169], v248, s[64:67], 0 offen offset:192
    buffer_load_dwordx4 v[170:173], v248, s[64:67], s85 offen offset:256
    s_mov_b64 exec, -1
    s_lshl_b32 s98, s80, 3
    s_add_u32 s98, s98, s3
    s_lshl_b32 s98, s98, 13
    s_add_u32 m0, s79, 32768
    s_nop 0
    buffer_load_dwordx4 v249, s[40:43], s98 offen nt lds
    s_add_u32 s98, s98, 262144
    s_add_u32 m0, s79, 33792
    s_nop 0
    buffer_load_dwordx4 v249, s[40:43], s98 offen nt lds
    s_add_u32 s98, s98, 262144
    s_add_u32 m0, s79, 34816
    s_nop 0
    buffer_load_dwordx4 v249, s[40:43], s98 offen nt lds
    s_add_u32 s98, s98, 262144
    s_add_u32 m0, s79, 35840
    s_nop 0
    buffer_load_dwordx4 v249, s[40:43], s98 offen nt lds
    s_add_u32 s98, s98, 262144
    s_add_u32 m0, s79, 36864
    s_add_u32 s98, s98, s85
    buffer_load_dwordx4 v249, s[40:43], s98 offen nt lds
    s_add_u32 s36, s8, s101
    s_addc_u32 s37, s9, 0
    s_mov_b32 s38, 131072
    s_mov_b32 s39, 0x20000
    s_add_u32 m0, s79, 4096
    s_nop 0
    buffer_load_dwordx4 v34, s[32:35], s84 offen nt lds
    s_add_u32 s84, s84, 4096
    s_and_b32 s84, s84, 0x1ffff
    s_add_u32 m0, s79, 5120
    s_nop 0
    buffer_load_dwordx4 v35, s[32:35], s84 offen nt lds
    s_add_u32 s84, s84, 4096
    s_and_b32 s84, s84, 0x1ffff
    s_add_u32 m0, s79, 6144
    s_nop 0
    buffer_load_dwordx4 v36, s[32:35], s84 offen nt lds
    s_add_u32 s84, s84, 4096
    s_and_b32 s84, s84, 0x1ffff
    s_add_u32 m0, s79, 7168
    s_nop 0
    buffer_load_dwordx4 v37, s[32:35], s84 offen nt lds
    s_add_u32 s84, s84, 4096
    s_and_b32 s84, s84, 0x1ffff
    s_lshl_b32 s98, s3, 3
    v_lshlrev_b32 v4, 6, v239
    v_lshl_add_u32 v4, v240, 4, v4
    s_mul_i32 s3, s80, 160
    s_cmp_eq_u32 s80, 3
    s_cselect_b32 s3, 448, s3
    s_lshl_b32 s99, s3, 3
    v_add_u32 v3, s99, v4
    v_add_u32 v4, s98, v4
    s_cmp_ge_u32 s80, 2
    s_cselect_b32 s77, 0x40000000, 0
    s_mov_b32 s60, s24
    s_mov_b32 s61, s25
    s_mov_b32 s62, 4608
    s_mov_b32 s63, 0x20000
    s_mov_b32 s68, s26
    s_mov_b32 s69, s27
    s_mov_b32 s70, 256
    s_mov_b32 s71, 0x20000
    s_getreg_b32 s26, hwreg(HW_REG_XCC_ID, 0, 4)
    s_or_b32 s26, s26, 16
    s_mov_b32 s29, 0x3ae38e39
    s_mov_b32 s30, 0x3727c5ac
    s_mov_b32 s86, 0x3e0293ee
    s_mov_b32 s83, 20000
    s_mov_b32 s85, 0
    s_lshl_b32 s78, s81, 7
    s_add_u32 s78, s78, 1490944
    s_cmp_eq_u32 s80, 0
    s_cselect_b32 s78, s78, 0x40000000
    v_mov_b32 v51, 1
    v_mov_b32 v14, 0
    v_mov_b32 v15, 0
    v_mov_b32 v28, 0
    s_add_u32 s88, s87, 0
    s_add_u32 s89, s87, 32768
    s_add_u32 s92, s87, 33792
    s_add_u32 s93, s87, 47616
    s_and_b32 s98, s82, 1
    s_lshl_b32 s98, s98, 1
    s_add_u32 s99, s98, s80
    s_lshl_b32 s99, s99, 12
    s_bfe_u32 s100, s82, 0x20001
    s_lshr_b32 s101, s82, 3
    s_lshl_b32 s27, s100, 2
    s_add_u32 s27, s27, s101
    s_lshl_b32 s27, s27, 6
    s_add_u32 s27, s27, s99
    s_add_u32 s27, s27, s88
    s_lshl_b32 s99, s98, 2
    s_add_u32 s99, s99, s100
    s_lshl_b32 s99, s99, 5
    s_lshl_b32 s101, s101, 2
    s_add_u32 s99, s99, s101
    s_add_u32 s28, s99, s89
    s_lshl_b32 s98, s98, 1
    s_add_u32 s98, s98, s80
    s_lshl_b32 s98, s98, 7
    s_lshl_b32 s100, s100, 5
    s_add_u32 s98, s98, s100
    s_add_u32 s74, s73, s98
    v_lshlrev_b32 v2, 2, v1
    v_lshl_add_u32 v241, v239, 8, s79
    v_xor_b32 v246, v240, v239
    v_lshl_add_u32 v38, v246, 4, v241
    v_xor_b32 v39, 64, v38
    v_xor_b32 v40, 128, v38
    v_xor_b32 v41, 192, v38
    v_lshrrev_b32 v246, 2, v1
    v_lshl_add_u32 v241, v246, 8, s79
    v_and_b32 v247, 1, v1
    v_lshl_add_u32 v241, v247, 3, v241
    v_bfe_u32 v247, v1, 1, 1
    v_xor_b32 v247, v247, v246
    v_lshl_add_u32 v42, v247, 4, v241
    v_xor_b32 v43, 32, v42
    v_xor_b32 v44, 64, v42
    v_xor_b32 v45, 96, v42
    v_xor_b32 v46, 128, v42
    v_xor_b32 v47, 160, v42
    v_xor_b32 v48, 192, v42
    v_xor_b32 v49, 224, v42
    v_and_b32 v247, 3, v1
    v_lshlrev_b32 v247, 3, v247
    v_bfe_u32 v248, v1, 2, 2
    v_lshl_add_u32 v247, v248, 7, v247
    v_bfe_u32 v248, v1, 3, 2
    v_xor_b32 v248, s80, v248
    v_lshl_add_u32 v247, v248, 5, v247
    v_mov_b32 v248, 37888
    v_mad_u32_u24 v50, v240, v248, v247
    s_mul_i32 s98, s80, 1280
    s_add_u32 s98, s98, 151552
    v_lshlrev_b32 v16, 6, v239
    v_lshl_add_u32 v16, v240, 4, v16
    v_add_u32 v16, s98, v16
    v_add_u32 v17, s98, v2
    s_mul_i32 s98, s80, 320
    s_add_u32 s98, s98, 151552
    v_add_u32 v18, s98, v2
    s_add_u32 s98, s98, 256
    v_lshl_add_u32 v31, v239, 2, s98
    s_lshl_b32 s98, s80, 3
    s_add_u32 s98, s98, 156672
    v_lshl_add_u32 v19, v239, 5, s98
    v_add_u32 v248, 4, v19
    v_cmp_gt_u32 vcc, 16, v1
    v_mov_b32 v249, 156800
    s_nop 0
    v_cndmask_b32 v19, v19, v248, vcc
    v_and_b32 v248, 44, v1
    v_cmp_eq_u32 vcc, 0, v248
    v_lshlrev_b32 v20, 5, v240
    v_add_u32 v20, 156672, v20
    v_cndmask_b32 v19, v249, v19, vcc
    s_lshl_b32 s98, s80, 10
    s_add_u32 s98, s98, 157696
    v_and_b32 v247, 1, v1
    v_lshlrev_b32 v21, 9, v247
    v_lshl_add_u32 v21, v240, 4, v21
    v_add_u32 v21, s98, v21
    s_lshl_b32 s98, s80, 9
    s_add_u32 s98, s98, 157696
    v_lshl_add_u32 v22, v1, 3, s98
    v_lshlrev_b32 v24, 4, v247
    v_add_u32 v24, 156928, v24
    s_lshl_b32 s98, s80, 2
    v_add_u32 v23, s98, v24
    s_lshl_b32 s98, s80, 4
    s_add_u32 s98, s98, 156928
    v_mov_b32 v53, s98
    s_cmp_gt_u32 s80, 1
    s_cselect_b64 vcc, -1, 0
    v_cndmask_b32 v53, v53, v24, vcc
    v_lshlrev_b32 v13, 7, v247
    v_lshlrev_b32 v9, 8, v247
    v_lshl_add_u32 v9, v240, 4, v9
    v_add_u32 v9, 157184, v9
    s_lshl_b32 s98, s80, 7
    s_add_u32 s98, s98, 157184
    v_lshl_add_u32 v8, v1, 1, s98
    s_bfe_u32 s98, s82, 0x20001
    s_lshl_b32 s98, s98, 13
    s_and_b32 s99, s82, 1
    s_lshl_b32 s99, s99, 10
    s_add_u32 s98, s98, s99
    s_lshl_b32 s99, s80, 8
    s_add_u32 s98, s98, s99
    v_add_u32 v5, s98, v2
    v_lshlrev_b32 v10, 10, v240
    v_lshl_add_u32 v10, v239, 2, v10
    s_lshl_b32 s98, s80, 11
    v_lshlrev_b32 v11, 6, v239
    v_lshl_add_u32 v11, v240, 4, v11
    v_add_u32 v11, s98, v11
    s_lshr_b32 s98, s80, 1
    s_lshl_b32 s98, s98, 7
    v_lshl_add_u32 v12, v240, 5, s98
    s_mov_b32 s90, 0
    s_mov_b32 s91, 0
    s_add_u32 m0, s79, 8192
    s_nop 0
    buffer_load_dwordx4 v34, s[32:35], s84 offen nt lds
    s_add_u32 s84, s84, 4096
    s_and_b32 s84, s84, 0x1ffff
    s_add_u32 m0, s79, 9216
    s_nop 0
    buffer_load_dwordx4 v35, s[32:35], s84 offen nt lds
    s_add_u32 s84, s84, 4096
    s_and_b32 s84, s84, 0x1ffff
    s_add_u32 m0, s79, 10240
    s_nop 0
    buffer_load_dwordx4 v36, s[32:35], s84 offen nt lds
    s_add_u32 s84, s84, 4096
    s_and_b32 s84, s84, 0x1ffff
    s_add_u32 m0, s79, 11264
    s_nop 0
    buffer_load_dwordx4 v37, s[32:35], s84 offen nt lds
    s_add_u32 s84, s84, 4096
    s_and_b32 s84, s84, 0x1ffff
    s_waitcnt vmcnt(8)
    s_barrier
    ds_read_b64_tr_b16 v[54:55], v50 offset:32768
    ds_read_b64_tr_b16 v[56:57], v50 offset:33280
    ds_read_b64_tr_b16 v[58:59], v50 offset:33792
    ds_read_b64_tr_b16 v[60:61], v50 offset:34304
    ds_read_b64_tr_b16 v[62:63], v50 offset:34816
    ds_read_b64_tr_b16 v[64:65], v50 offset:35328
    ds_read_b64_tr_b16 v[66:67], v50 offset:35840
    ds_read_b64_tr_b16 v[68:69], v50 offset:36352
    ds_read_b64_tr_b16 v[70:71], v50 offset:36864
    ds_read_b64_tr_b16 v[72:73], v50 offset:37376
    v_mfma_f32_16x16x32_bf16 v[202:205], v[154:157], v[154:157], 0
    v_mfma_f32_16x16x32_bf16 v[202:205], v[158:161], v[158:161], v[202:205]
    v_mfma_f32_16x16x32_bf16 v[202:205], v[162:165], v[162:165], v[202:205]
    v_mfma_f32_16x16x32_bf16 v[202:205], v[166:169], v[166:169], v[202:205]
    v_mfma_f32_16x16x32_bf16 v[202:205], v[170:173], v[170:173], v[202:205]
    s_waitcnt lgkmcnt(0)
    v_mfma_f32_16x16x32_bf16 v[206:209], v[54:57], v[154:157], 0
    v_mfma_f32_16x16x32_bf16 v[206:209], v[58:61], v[158:161], v[206:209]
    v_mfma_f32_16x16x32_bf16 v[206:209], v[62:65], v[162:165], v[206:209]
    v_mfma_f32_16x16x32_bf16 v[206:209], v[66:69], v[166:169], v[206:209]
    v_mfma_f32_16x16x32_bf16 v[206:209], v[70:73], v[170:173], v[206:209]
    s_mov_b64 s[96:97], 2
    s_nop 0
    v_cndmask_b32 v202, v202, v203, s[96:97]
    s_mov_b64 s[96:97], 4
    v_cndmask_b32 v202, v202, v204, s[96:97]
    s_mov_b64 s[96:97], 8
    v_cndmask_b32 v202, v202, v205, s[96:97]
    s_mov_b32 exec_lo, 0x001f001f
    s_mov_b32 exec_hi, 0x001f001f
    buffer_store_dwordx4 v[206:209], v6, s[48:51], s72 offen sc1
    s_cmp_lg_u32 s80, 0
    s_cbranch_scc1 Lnf3
    s_mov_b32 exec_lo, 0x000f000f
    s_mov_b32 exec_hi, 0
    buffer_store_dword v202, v7, s[48:51], s73 offen sc1
    v_mov_b32 v238, s26
    v_mov_b32 v239, s2
    s_mov_b64 exec, 1
    buffer_store_byte v238, v239, s[68:71], 0 offen sc1
Lnf3:
    s_mov_b64 exec, -1
    s_waitcnt vmcnt(19)
    s_add_u32 m0, s79, 12288
    s_nop 0
    buffer_load_dwordx4 v34, s[32:35], s84 offen nt lds
    s_add_u32 s84, s84, 4096
    s_and_b32 s84, s84, 0x1ffff
    s_add_u32 m0, s79, 13312
    s_nop 0
    buffer_load_dwordx4 v35, s[32:35], s84 offen nt lds
    s_add_u32 s84, s84, 4096
    s_and_b32 s84, s84, 0x1ffff
    s_add_u32 m0, s79, 14336
    s_nop 0
    buffer_load_dwordx4 v36, s[32:35], s84 offen nt lds
    s_add_u32 s84, s84, 4096
    s_and_b32 s84, s84, 0x1ffff
    s_add_u32 m0, s79, 15360
    s_nop 0
    buffer_load_dwordx4 v37, s[32:35], s84 offen nt lds
    s_add_u32 s84, s84, 4096
    s_and_b32 s84, s84, 0x1ffff
    ds_read_b128 a[0:3], v38 offset:0
    ds_read_b128 a[4:7], v39 offset:0
    ds_read_b128 a[8:11], v40 offset:0
    ds_read_b128 a[12:15], v41 offset:0
    s_waitcnt vmcnt(9)
    s_waitcnt lgkmcnt(0)
    s_add_u32 m0, s79, 0
    s_nop 0
    buffer_load_dwordx4 v34, s[32:35], s84 offen nt lds
    s_add_u32 s84, s84, 4096
    s_and_b32 s84, s84, 0x1ffff
    s_add_u32 m0, s79, 1024
    s_nop 0
    buffer_load_dwordx4 v35, s[32:35], s84 offen nt lds
    s_add_u32 s84, s84, 4096
    s_and_b32 s84, s84, 0x1ffff
    s_add_u32 m0, s79, 2048
    s_nop 0
    buffer_load_dwordx4 v36, s[32:35], s84 offen nt lds
    s_add_u32 s84, s84, 4096
    s_and_b32 s84, s84, 0x1ffff
    s_add_u32 m0, s79, 3072
    s_nop 0
    buffer_load_dwordx4 v37, s[32:35], s84 offen nt lds
    s_add_u32 s84, s84, 4096
    s_and_b32 s84, s84, 0x1ffff
    ds_read_b128 a[16:19], v38 offset:4096
    ds_read_b128 a[20:23], v39 offset:4096
    ds_read_b128 a[24:27], v40 offset:4096
    ds_read_b128 a[28:31], v41 offset:4096
    s_waitcnt vmcnt(9)
    s_waitcnt lgkmcnt(0)
    s_add_u32 m0, s79, 4096
    s_nop 0
    buffer_load_dwordx4 v34, s[32:35], s84 offen nt lds
    s_add_u32 s84, s84, 4096
    s_and_b32 s84, s84, 0x1ffff
    s_add_u32 m0, s79, 5120
    s_nop 0
    buffer_load_dwordx4 v35, s[32:35], s84 offen nt lds
    s_add_u32 s84, s84, 4096
    s_and_b32 s84, s84, 0x1ffff
    s_add_u32 m0, s79, 6144
    s_nop 0
    buffer_load_dwordx4 v36, s[32:35], s84 offen nt lds
    s_add_u32 s84, s84, 4096
    s_and_b32 s84, s84, 0x1ffff
    s_add_u32 m0, s79, 7168
    s_nop 0
    buffer_load_dwordx4 v37, s[32:35], s84 offen nt lds
    s_add_u32 s84, s84, 4096
    s_and_b32 s84, s84, 0x1ffff
    ds_read_b128 a[32:35], v38 offset:8192
    ds_read_b128 a[36:39], v39 offset:8192
    ds_read_b128 a[40:43], v40 offset:8192
    ds_read_b128 a[44:47], v41 offset:8192
    s_waitcnt vmcnt(8)
    s_waitcnt lgkmcnt(0)
    s_add_u32 m0, s79, 8192
    s_nop 0
    buffer_load_dwordx4 v34, s[32:35], s84 offen nt lds
    s_add_u32 s84, s84, 4096
    s_and_b32 s84, s84, 0x1ffff
    s_add_u32 m0, s79, 9216
    s_nop 0
    buffer_load_dwordx4 v35, s[32:35], s84 offen nt lds
    s_add_u32 s84, s84, 4096
    s_and_b32 s84, s84, 0x1ffff
    s_add_u32 m0, s79, 10240
    s_nop 0
    buffer_load_dwordx4 v36, s[32:35], s84 offen nt lds
    s_add_u32 s84, s84, 4096
    s_and_b32 s84, s84, 0x1ffff
    s_add_u32 m0, s79, 11264
    s_nop 0
    buffer_load_dwordx4 v37, s[32:35], s84 offen nt lds
    s_add_u32 s84, s84, 4096
    s_and_b32 s84, s84, 0x1ffff
    ds_read_b128 a[48:51], v38 offset:12288
    ds_read_b128 a[52:55], v39 offset:12288
    ds_read_b128 a[56:59], v40 offset:12288
    ds_read_b128 a[60:63], v41 offset:12288
    s_waitcnt vmcnt(8)
    s_waitcnt lgkmcnt(0)
    s_add_u32 m0, s79, 12288
    s_nop 0
    buffer_load_dwordx4 v34, s[32:35], s84 offen nt lds
    s_add_u32 s84, s84, 4096
    s_and_b32 s84, s84, 0x1ffff
    s_add_u32 m0, s79, 13312
    s_nop 0
    buffer_load_dwordx4 v35, s[32:35], s84 offen nt lds
    s_add_u32 s84, s84, 4096
    s_and_b32 s84, s84, 0x1ffff
    s_add_u32 m0, s79, 14336
    s_nop 0
    buffer_load_dwordx4 v36, s[32:35], s84 offen nt lds
    s_add_u32 s84, s84, 4096
    s_and_b32 s84, s84, 0x1ffff
    s_add_u32 m0, s79, 15360
    s_nop 0
    buffer_load_dwordx4 v37, s[32:35], s84 offen nt lds
    s_add_u32 s84, s84, 4096
    s_and_b32 s84, s84, 0x1ffff
    ds_read_b128 a[64:67], v38 offset:0
    ds_read_b128 a[68:71], v39 offset:0
    ds_read_b128 a[72:75], v40 offset:0
    ds_read_b128 a[76:79], v41 offset:0
    s_waitcnt vmcnt(8)
    s_waitcnt lgkmcnt(0)
    s_add_u32 m0, s79, 0
    s_nop 0
    buffer_load_dwordx4 v34, s[36:39], s84 offen nt lds
    s_add_u32 s84, s84, 4096
    s_and_b32 s84, s84, 0x1ffff
    s_add_u32 m0, s79, 1024
    s_nop 0
    buffer_load_dwordx4 v35, s[36:39], s84 offen nt lds
    s_add_u32 s84, s84, 4096
    s_and_b32 s84, s84, 0x1ffff
    s_add_u32 m0, s79, 2048
    s_nop 0
    buffer_load_dwordx4 v36, s[36:39], s84 offen nt lds
    s_add_u32 s84, s84, 4096
    s_and_b32 s84, s84, 0x1ffff
    s_add_u32 m0, s79, 3072
    s_nop 0
    buffer_load_dwordx4 v37, s[36:39], s84 offen nt lds
    s_add_u32 s84, s84, 4096
    s_and_b32 s84, s84, 0x1ffff
    ds_read_b128 a[80:83], v38 offset:4096
    ds_read_b128 a[84:87], v39 offset:4096
    ds_read_b128 a[88:91], v40 offset:4096
    ds_read_b128 a[92:95], v41 offset:4096
    s_waitcnt vmcnt(8)
    buffer_load_dword v33, v2, s[68:71], 0 offen
    s_waitcnt lgkmcnt(0)
    s_add_u32 m0, s79, 4096
    s_nop 0
    buffer_load_dwordx4 v34, s[36:39], s84 offen nt lds
    s_add_u32 s84, s84, 4096
    s_and_b32 s84, s84, 0x1ffff
    s_add_u32 m0, s79, 5120
    s_nop 0
    buffer_load_dwordx4 v35, s[36:39], s84 offen nt lds
    s_add_u32 s84, s84, 4096
    s_and_b32 s84, s84, 0x1ffff
    s_add_u32 m0, s79, 6144
    s_nop 0
    buffer_load_dwordx4 v36, s[36:39], s84 offen nt lds
    s_add_u32 s84, s84, 4096
    s_and_b32 s84, s84, 0x1ffff
    s_add_u32 m0, s79, 7168
    s_nop 0
    buffer_load_dwordx4 v37, s[36:39], s84 offen nt lds
    s_add_u32 s84, s84, 4096
    s_and_b32 s84, s84, 0x1ffff
    ds_read_b128 a[96:99], v38 offset:8192
    ds_read_b128 a[100:103], v39 offset:8192
    ds_read_b128 a[104:107], v40 offset:8192
    ds_read_b128 a[108:111], v41 offset:8192
    s_waitcnt vmcnt(9)
    s_waitcnt lgkmcnt(0)
    s_add_u32 m0, s79, 8192
    s_nop 0
    buffer_load_dwordx4 v34, s[36:39], s84 offen nt lds
    s_add_u32 s84, s84, 4096
    s_and_b32 s84, s84, 0x1ffff
    s_add_u32 m0, s79, 9216
    s_nop 0
    buffer_load_dwordx4 v35, s[36:39], s84 offen nt lds
    s_add_u32 s84, s84, 4096
    s_and_b32 s84, s84, 0x1ffff
    s_add_u32 m0, s79, 10240
    s_nop 0
    buffer_load_dwordx4 v36, s[36:39], s84 offen nt lds
    s_add_u32 s84, s84, 4096
    s_and_b32 s84, s84, 0x1ffff
    s_add_u32 m0, s79, 11264
    s_nop 0
    buffer_load_dwordx4 v37, s[36:39], s84 offen nt lds
    s_add_u32 s84, s84, 4096
    s_and_b32 s84, s84, 0x1ffff
    ds_read_b128 a[112:115], v38 offset:12288
    ds_read_b128 a[116:119], v39 offset:12288
    ds_read_b128 a[120:123], v40 offset:12288
    ds_read_b128 a[124:127], v41 offset:12288
    s_waitcnt vmcnt(9)
    s_waitcnt vmcnt(8)
    v_and_b32 v239, 0x10101010, v33
    s_mov_b32 s98, 0x10101010
    v_cmp_ne_u32 vcc, s98, v239
    s_nop 0
    s_or_b32 s25, vcc_lo, vcc_hi
    s_cselect_b32 s98, 0x40000000, s78
    s_add_u32 s101, s72, 4096
    s_mov_b64 exec, 1
    buffer_atomic_add v51, off, s[48:51], s98 sc0 sc1
    s_mov_b64 exec, -1
    buffer_load_dword v190, v5, s[48:51], s72 offen sc1
    buffer_load_dword v191, v5, s[48:51], s72 offen offset:2048 sc1
    buffer_load_dword v192, v5, s[48:51], s101 offen sc1
    buffer_load_dword v193, v5, s[48:51], s101 offen offset:2048 sc1
    buffer_load_dwordx4 v[194:197], off, s[48:51], s74 sc1
    buffer_load_dwordx4 v[198:201], off, s[48:51], s74 offset:16 sc1
    s_bfe_u32 s98, s82, 0x20001
    s_sub_u32 s98, 4, s98
    s_lshl_b32 s98, s98, 13
    s_add_u32 s98, s98, s72
    s_add_u32 s99, s98, 4096
    buffer_load_dword v234, v5, s[48:51], s98 offen sc1
    buffer_load_dword v235, v5, s[48:51], s98 offen offset:2048 sc1
    buffer_load_dword v236, v5, s[48:51], s99 offen sc1
    buffer_load_dword v237, v5, s[48:51], s99 offen offset:2048 sc1
    s_waitcnt lgkmcnt(0)
    s_add_u32 m0, s79, 12288
    s_nop 0
    buffer_load_dwordx4 v34, s[36:39], s84 offen nt lds
    s_add_u32 s84, s84, 4096
    s_and_b32 s84, s84, 0x1ffff
    s_add_u32 m0, s79, 13312
    s_nop 0
    buffer_load_dwordx4 v35, s[36:39], s84 offen nt lds
    s_add_u32 s84, s84, 4096
    s_and_b32 s84, s84, 0x1ffff
    s_add_u32 m0, s79, 14336
    s_nop 0
    buffer_load_dwordx4 v36, s[36:39], s84 offen nt lds
    s_add_u32 s84, s84, 4096
    s_and_b32 s84, s84, 0x1ffff
    s_add_u32 m0, s79, 15360
    s_nop 0
    buffer_load_dwordx4 v37, s[36:39], s84 offen nt lds
    s_add_u32 s84, s84, 4096
    s_and_b32 s84, s84, 0x1ffff
    ds_read_b64_tr_b16 a[128:129], v42 offset:0
    ds_read_b64_tr_b16 a[132:133], v43 offset:0
    ds_read_b64_tr_b16 a[136:137], v44 offset:0
    ds_read_b64_tr_b16 a[140:141], v45 offset:0
    ds_read_b64_tr_b16 a[144:145], v46 offset:0
    ds_read_b64_tr_b16 a[148:149], v47 offset:0
    ds_read_b64_tr_b16 a[152:153], v48 offset:0
    ds_read_b64_tr_b16 a[156:157], v49 offset:0
    s_waitcnt vmcnt(19)
    s_waitcnt lgkmcnt(0)
    s_add_u32 m0, s79, 0
    s_nop 0
    buffer_load_dwordx4 v34, s[36:39], s84 offen nt lds
    s_add_u32 s84, s84, 4096
    s_and_b32 s84, s84, 0x1ffff
    s_add_u32 m0, s79, 1024
    s_nop 0
    buffer_load_dwordx4 v35, s[36:39], s84 offen nt lds
    s_add_u32 s84, s84, 4096
    s_and_b32 s84, s84, 0x1ffff
    s_add_u32 m0, s79, 2048
    s_nop 0
    buffer_load_dwordx4 v36, s[36:39], s84 offen nt lds
    s_add_u32 s84, s84, 4096
    s_and_b32 s84, s84, 0x1ffff
    s_add_u32 m0, s79, 3072
    s_nop 0
    buffer_load_dwordx4 v37, s[36:39], s84 offen nt lds
    s_add_u32 s84, s84, 4096
    s_and_b32 s84, s84, 0x1ffff
    ds_read_b64_tr_b16 a[130:131], v42 offset:4096
    ds_read_b64_tr_b16 a[134:135], v43 offset:4096
    ds_read_b64_tr_b16 a[138:139], v44 offset:4096
    ds_read_b64_tr_b16 a[142:143], v45 offset:4096
    ds_read_b64_tr_b16 a[146:147], v46 offset:4096
    ds_read_b64_tr_b16 a[150:151], v47 offset:4096
    ds_read_b64_tr_b16 a[154:155], v48 offset:4096
    ds_read_b64_tr_b16 a[158:159], v49 offset:4096
    s_waitcnt vmcnt(19)
    s_waitcnt lgkmcnt(0)
    s_add_u32 m0, s79, 4096
    s_nop 0
    buffer_load_dwordx4 v34, s[36:39], s84 offen nt lds
    s_add_u32 s84, s84, 4096
    s_and_b32 s84, s84, 0x1ffff
    s_add_u32 m0, s79, 5120
    s_nop 0
    buffer_load_dwordx4 v35, s[36:39], s84 offen nt lds
    s_add_u32 s84, s84, 4096
    s_and_b32 s84, s84, 0x1ffff
    s_add_u32 m0, s79, 6144
    s_nop 0
    buffer_load_dwordx4 v36, s[36:39], s84 offen nt lds
    s_add_u32 s84, s84, 4096
    s_and_b32 s84, s84, 0x1ffff
    s_add_u32 m0, s79, 7168
    s_nop 0
    buffer_load_dwordx4 v37, s[36:39], s84 offen nt lds
    s_add_u32 s84, s84, 4096
    s_and_b32 s84, s84, 0x1ffff
    ds_read_b64_tr_b16 a[160:161], v42 offset:8192
    ds_read_b64_tr_b16 a[164:165], v43 offset:8192
    ds_read_b64_tr_b16 a[168:169], v44 offset:8192
    ds_read_b64_tr_b16 a[172:173], v45 offset:8192
    ds_read_b64_tr_b16 a[176:177], v46 offset:8192
    ds_read_b64_tr_b16 a[180:181], v47 offset:8192
    ds_read_b64_tr_b16 a[184:185], v48 offset:8192
    ds_read_b64_tr_b16 a[188:189], v49 offset:8192
    s_cmp_eq_u32 s25, 0
    s_cbranch_scc1 Ltq6
Ltq4:
    buffer_load_dword v33, v2, s[68:71], 0 offen sc1
    s_waitcnt vmcnt(0)
    v_and_b32 v239, 0x10101010, v33
    s_mov_b32 s98, 0x10101010
    v_cmp_ne_u32 vcc, s98, v239
    s_cbranch_vccz Lok7
    s_sub_u32 s83, s83, 1
    s_cbranch_scc0 Ltq4
    s_mov_b32 s83, 0
Lok7:
    v_mov_b32 v51, 1
    s_mov_b32 s98, s78
    s_mov_b64 exec, 1
    buffer_atomic_add v51, off, s[48:51], s98 sc0 sc1
    s_mov_b64 exec, -1
Ltq5:
    s_add_u32 s101, s72, 4096
    buffer_load_dword v190, v5, s[48:51], s72 offen sc1
    buffer_load_dword v191, v5, s[48:51], s72 offen offset:2048 sc1
    buffer_load_dword v192, v5, s[48:51], s101 offen sc1
    buffer_load_dword v193, v5, s[48:51], s101 offen offset:2048 sc1
    buffer_load_dwordx4 v[194:197], off, s[48:51], s74 sc1
    buffer_load_dwordx4 v[198:201], off, s[48:51], s74 offset:16 sc1
    s_bfe_u32 s98, s82, 0x20001
    s_sub_u32 s98, 4, s98
    s_lshl_b32 s98, s98, 13
    s_add_u32 s98, s98, s72
    s_add_u32 s99, s98, 4096
    buffer_load_dword v234, v5, s[48:51], s98 offen sc1
    buffer_load_dword v235, v5, s[48:51], s98 offen offset:2048 sc1
    buffer_load_dword v236, v5, s[48:51], s99 offen sc1
    buffer_load_dword v237, v5, s[48:51], s99 offen offset:2048 sc1
    s_waitcnt vmcnt(0)
Ltq6:
    s_waitcnt vmcnt(12)
    v_pk_add_f32 v[238:239], v[194:195], v[196:197]
    v_pk_add_f32 v[240:241], v[198:199], v[200:201]
    v_pk_add_f32 v[242:243], v[190:191], v[192:193]
    v_pk_add_f32 v[238:239], v[238:239], v[240:241]
    v_mov_b32 v244, s30
    v_add_f32 v242, v242, v243
    v_mul_f32 v238, s29, v238
    v_fma_f32 v239, v239, s29, v244
    v_pk_add_f32 v[240:241], v[234:235], v[236:237]
    v_add_f32 v30, v240, v241
    v_fma_f32 v239, -v238, v238, v239
    v_rsq_f32 v239, v239
    v_fma_f32 v242, -v238, v30, v242
    v_mul_f32 v242, v242, v239
    v_cmp_u_f32 vcc, v242, v242
    v_cvt_pk_bf16_f32 v242, v242, v242
    s_cbranch_vccz Lok8
    s_sub_u32 s83, s83, 1
    s_cbranch_scc0 Ltq5
    s_mov_b32 s83, 0
Lok8:
    s_mov_b64 exec, 1
    ds_write_b32 v23, v51 offset:64
    s_mov_b64 exec, -1
    ds_write_b16 v8, v242
    s_waitcnt lgkmcnt(0)
    s_barrier
    ds_read_b32 v51, v24 offset:64
    ds_read_b128 v[174:177], v9 offset:0
    ds_read_b128 v[178:181], v9 offset:64
    ds_read_b128 v[182:185], v9 offset:128
    ds_read_b128 v[186:189], v9 offset:192
    s_and_b32 s98, s2, 3
    s_lshl_b32 s98, s98, 3
    v_lshrrev_b32 v239, s98, v33
    v_and_b32 v239, 0xff, v239
    v_cmp_ne_u32 vcc, s26, v239
    s_mov_b32 s98, 0x55555555
    s_bfe_u32 s99, s2, 0x10002
    s_lshl_b32 s98, s98, s99
    s_and_b32 s99, vcc_lo, s98
    s_and_b32 s100, vcc_hi, s98
    s_or_b32 s99, s99, s100
    s_mov_b32 s52, s48
    s_mov_b32 s53, s49
    s_mov_b32 s56, s48
    s_mov_b32 s57, s49
    s_mov_b32 s55, 0x20000
    s_mov_b32 s59, 0x20000
    s_cmp_eq_u32 s99, 0
    s_cselect_b32 s54, 1908736, 0
    s_cselect_b32 s58, 0, 1908736
    s_waitcnt lgkmcnt(3)
    v_mfma_f32_16x16x32_bf16 v[234:237], a[0:3], v[174:177], 0
    s_waitcnt lgkmcnt(2)
    v_mfma_f32_16x16x32_bf16 v[234:237], a[4:7], v[178:181], v[234:237]
    s_waitcnt lgkmcnt(1)
    v_mfma_f32_16x16x32_bf16 v[234:237], a[8:11], v[182:185], v[234:237]
    s_waitcnt lgkmcnt(0)
    v_mfma_f32_16x16x32_bf16 v[234:237], a[12:15], v[186:189], v[234:237]
    v_mfma_f32_16x16x32_bf16 v[206:209], a[16:19], v[174:177], 0
    v_mfma_f32_16x16x32_bf16 v[206:209], a[20:23], v[178:181], v[206:209]
    v_mfma_f32_16x16x32_bf16 v[206:209], a[24:27], v[182:185], v[206:209]
    v_mfma_f32_16x16x32_bf16 v[206:209], a[28:31], v[186:189], v[206:209]
    v_mfma_f32_16x16x32_bf16 v[202:205], a[32:35], v[174:177], 0
    s_mov_b32 s96, 0xc000c
    s_mov_b32 s97, 0xc000c
    v_mfma_f32_16x16x32_bf16 v[202:205], a[36:39], v[178:181], v[202:205]
    v_mfma_f32_16x16x32_bf16 v[202:205], a[40:43], v[182:185], v[202:205]
    v_mfma_f32_16x16x32_bf16 v[202:205], a[44:47], v[186:189], v[202:205]
    s_nop 1
    v_cndmask_b32 v234, v234, v206, s[96:97]
    v_cndmask_b32 v235, v235, v207, s[96:97]
    v_cndmask_b32 v236, v236, v208, s[96:97]
    v_cndmask_b32 v237, v237, v209, s[96:97]
    v_mfma_f32_16x16x32_bf16 v[206:209], a[48:51], v[174:177], 0
    s_mov_b32 s96, 0x300030
    s_mov_b32 s97, 0x300030
    v_mfma_f32_16x16x32_bf16 v[206:209], a[52:55], v[178:181], v[206:209]
    v_mfma_f32_16x16x32_bf16 v[206:209], a[56:59], v[182:185], v[206:209]
    v_mfma_f32_16x16x32_bf16 v[206:209], a[60:63], v[186:189], v[206:209]
    v_cndmask_b32 v234, v234, v202, s[96:97]
    v_cndmask_b32 v235, v235, v203, s[96:97]
    v_cndmask_b32 v236, v236, v204, s[96:97]
    v_cndmask_b32 v237, v237, v205, s[96:97]
    v_mfma_f32_16x16x32_bf16 v[202:205], a[64:67], v[174:177], 0
    s_mov_b32 s96, 0xc000c0
    s_mov_b32 s97, 0xc000c0
    v_mfma_f32_16x16x32_bf16 v[202:205], a[68:71], v[178:181], v[202:205]
    v_mfma_f32_16x16x32_bf16 v[202:205], a[72:75], v[182:185], v[202:205]
    v_mfma_f32_16x16x32_bf16 v[202:205], a[76:79], v[186:189], v[202:205]
    v_cndmask_b32 v234, v234, v206, s[96:97]
    v_cndmask_b32 v235, v235, v207, s[96:97]
    v_cndmask_b32 v236, v236, v208, s[96:97]
    v_cndmask_b32 v237, v237, v209, s[96:97]
    v_mfma_f32_16x16x32_bf16 v[206:209], a[80:83], v[174:177], 0
    s_mov_b32 s96, 0x3000300
    s_mov_b32 s97, 0x3000300
    v_mfma_f32_16x16x32_bf16 v[206:209], a[84:87], v[178:181], v[206:209]
    v_mfma_f32_16x16x32_bf16 v[206:209], a[88:91], v[182:185], v[206:209]
    v_mfma_f32_16x16x32_bf16 v[206:209], a[92:95], v[186:189], v[206:209]
    v_cndmask_b32 v234, v234, v202, s[96:97]
    v_cndmask_b32 v235, v235, v203, s[96:97]
    v_cndmask_b32 v236, v236, v204, s[96:97]
    v_cndmask_b32 v237, v237, v205, s[96:97]
    v_mfma_f32_16x16x32_bf16 v[202:205], a[96:99], v[174:177], 0
    s_mov_b32 s96, 0xc000c00
    s_mov_b32 s97, 0xc000c00
    v_mfma_f32_16x16x32_bf16 v[202:205], a[100:103], v[178:181], v[202:205]
    v_mfma_f32_16x16x32_bf16 v[202:205], a[104:107], v[182:185], v[202:205]
    v_mfma_f32_16x16x32_bf16 v[202:205], a[108:111], v[186:189], v[202:205]
    v_cndmask_b32 v234, v234, v206, s[96:97]
    v_cndmask_b32 v235, v235, v207, s[96:97]
    v_cndmask_b32 v236, v236, v208, s[96:97]
    v_cndmask_b32 v237, v237, v209, s[96:97]
    v_mfma_f32_16x16x32_bf16 v[206:209], a[112:115], v[174:177], 0
    s_mov_b32 s96, 0x30003000
    s_mov_b32 s97, 0x30003000
    v_mfma_f32_16x16x32_bf16 v[206:209], a[116:119], v[178:181], v[206:209]
    v_mfma_f32_16x16x32_bf16 v[206:209], a[120:123], v[182:185], v[206:209]
    v_mfma_f32_16x16x32_bf16 v[206:209], a[124:127], v[186:189], v[206:209]
    v_cndmask_b32 v234, v234, v202, s[96:97]
    v_cndmask_b32 v235, v235, v203, s[96:97]
    v_cndmask_b32 v236, v236, v204, s[96:97]
    v_cndmask_b32 v237, v237, v205, s[96:97]
    s_mov_b32 s96, 0xc000c000
    s_mov_b32 s97, 0xc000c000
    s_nop 1
    v_cndmask_b32 v234, v234, v206, s[96:97]
    v_cndmask_b32 v235, v235, v207, s[96:97]
    v_cndmask_b32 v236, v236, v208, s[96:97]
    v_cndmask_b32 v237, v237, v209, s[96:97]
    v_max3_f32 v238, v234, v235, v236
    v_max_f32 v238, v238, v237
    s_nop 1
    v_max_f32_dpp v238, v238, v238 quad_perm:[2,3,0,1] row_mask:0xf bank_mask:0xf
    s_nop 1
    v_max_f32_dpp v238, v238, v238 row_ror:4 row_mask:0xf bank_mask:0xf
    s_nop 1
    v_max_f32_dpp v238, v238, v238 row_ror:8 row_mask:0xf bank_mask:0xf
    v_mov_b32 v239, v238
    s_nop 1
    v_permlane16_swap_b32 v238, v239
    v_max_f32 v238, v238, v239
    v_mov_b32 v239, v238
    s_nop 1
    v_permlane32_swap_b32 v238, v239
    v_max_f32 v238, v238, v239
    s_mov_b64 exec, 3
    ds_write_b32 v23, v238
    s_mov_b64 exec, -1
    s_waitcnt lgkmcnt(0)
    s_barrier
    ds_read_b128 v[242:245], v24
    s_waitcnt lgkmcnt(0)
    v_max3_f32 v238, v242, v243, v244
    v_max_f32 v238, v238, v245
    v_mul_f32 v240, s86, v238
    v_mul_f32 v241, -1.0, v240
    v_fma_f32 v234, v234, s86, v241
    v_fma_f32 v235, v235, s86, v241
    v_fma_f32 v236, v236, s86, v241
    v_fma_f32 v237, v237, s86, v241
    v_exp_f32 v234, v234
    v_exp_f32 v235, v235
    v_exp_f32 v236, v236
    v_exp_f32 v237, v237
    v_cvt_pk_bf16_f32 v174, v234, v235
    v_cvt_pk_bf16_f32 v175, v236, v237
    s_nop 0
    v_mov_b32_dpp v176, v174 row_shl:2 row_mask:0xf bank_mask:0xf bound_ctrl:0
    v_mov_b32_dpp v177, v175 row_shl:2 row_mask:0xf bank_mask:0xf bound_ctrl:0
    v_mov_b32_dpp v178, v174 row_shl:4 row_mask:0xf bank_mask:0xf bound_ctrl:0
    v_mov_b32_dpp v179, v175 row_shl:4 row_mask:0xf bank_mask:0xf bound_ctrl:0
    v_mov_b32_dpp v180, v174 row_shl:6 row_mask:0xf bank_mask:0xf bound_ctrl:0
    v_mov_b32_dpp v181, v175 row_shl:6 row_mask:0xf bank_mask:0xf bound_ctrl:0
    v_mov_b32_dpp v182, v174 row_shl:8 row_mask:0xf bank_mask:0xf bound_ctrl:0
    v_mov_b32_dpp v183, v175 row_shl:8 row_mask:0xf bank_mask:0xf bound_ctrl:0
    v_mov_b32_dpp v184, v174 row_shl:10 row_mask:0xf bank_mask:0xf bound_ctrl:0
    v_mov_b32_dpp v185, v175 row_shl:10 row_mask:0xf bank_mask:0xf bound_ctrl:0
    v_mov_b32_dpp v186, v174 row_shl:12 row_mask:0xf bank_mask:0xf bound_ctrl:0
    v_mov_b32_dpp v187, v175 row_shl:12 row_mask:0xf bank_mask:0xf bound_ctrl:0
    v_mov_b32_dpp v188, v174 row_shl:14 row_mask:0xf bank_mask:0xf bound_ctrl:0
    v_mov_b32_dpp v189, v175 row_shl:14 row_mask:0xf bank_mask:0xf bound_ctrl:0
    v_add_f32 v234, v234, v235
    v_add_f32 v236, v236, v237
    v_add_f32 v234, v234, v236
    s_nop 1
    v_add_f32_dpp v234, v234, v234 quad_perm:[2,3,0,1] row_mask:0xf bank_mask:0xf
    s_nop 1
    v_add_f32_dpp v234, v234, v234 row_ror:4 row_mask:0xf bank_mask:0xf
    s_nop 1
    v_add_f32_dpp v234, v234, v234 row_ror:8 row_mask:0xf bank_mask:0xf
    v_mov_b32 v235, v234
    s_nop 1
    v_permlane16_swap_b32 v234, v235
    v_add_f32 v234, v234, v235
    v_mov_b32 v235, v234
    s_nop 1
    v_permlane32_swap_b32 v234, v235
    v_add_f32 v234, v234, v235
    s_mov_b64 exec, 3
    ds_write_b32 v23, v234 offset:32
    s_mov_b64 exec, -1
    s_waitcnt lgkmcnt(0)
    v_mfma_f32_16x16x32_bf16 v[202:205], a[128:131], v[174:177], 0
    v_mfma_f32_16x16x32_bf16 v[206:209], a[132:135], v[174:177], 0
    v_mfma_f32_16x16x32_bf16 v[210:213], a[136:139], v[174:177], 0
    v_mfma_f32_16x16x32_bf16 v[214:217], a[140:143], v[174:177], 0
    v_mfma_f32_16x16x32_bf16 v[218:221], a[144:147], v[174:177], 0
    v_mfma_f32_16x16x32_bf16 v[222:225], a[148:151], v[174:177], 0
    v_mfma_f32_16x16x32_bf16 v[226:229], a[152:155], v[174:177], 0
    v_mfma_f32_16x16x32_bf16 v[230:233], a[156:159], v[174:177], 0
    s_waitcnt vmcnt(8)
    s_waitcnt lgkmcnt(0)
    s_add_u32 m0, s79, 8192
    s_nop 0
    buffer_load_dwordx4 v34, s[36:39], s84 offen nt lds
    s_add_u32 s84, s84, 4096
    s_and_b32 s84, s84, 0x1ffff
    s_add_u32 m0, s79, 9216
    s_nop 0
    buffer_load_dwordx4 v35, s[36:39], s84 offen nt lds
    s_add_u32 s84, s84, 4096
    s_and_b32 s84, s84, 0x1ffff
    s_add_u32 m0, s79, 10240
    s_nop 0
    buffer_load_dwordx4 v36, s[36:39], s84 offen nt lds
    s_add_u32 s84, s84, 4096
    s_and_b32 s84, s84, 0x1ffff
    s_add_u32 m0, s79, 11264
    s_nop 0
    buffer_load_dwordx4 v37, s[36:39], s84 offen nt lds
    s_add_u32 s84, s84, 4096
    s_and_b32 s84, s84, 0x1ffff
    ds_read_b64_tr_b16 a[162:163], v42 offset:12288
    ds_read_b64_tr_b16 a[166:167], v43 offset:12288
    ds_read_b64_tr_b16 a[170:171], v44 offset:12288
    ds_read_b64_tr_b16 a[174:175], v45 offset:12288
    ds_read_b64_tr_b16 a[178:179], v46 offset:12288
    ds_read_b64_tr_b16 a[182:183], v47 offset:12288
    ds_read_b64_tr_b16 a[186:187], v48 offset:12288
    ds_read_b64_tr_b16 a[190:191], v49 offset:12288
    s_waitcnt lgkmcnt(0)
    v_mfma_f32_16x16x32_bf16 v[202:205], a[160:163], v[178:181], v[202:205]
    v_mfma_f32_16x16x32_bf16 v[206:209], a[164:167], v[178:181], v[206:209]
    v_mfma_f32_16x16x32_bf16 v[210:213], a[168:171], v[178:181], v[210:213]
    v_mfma_f32_16x16x32_bf16 v[214:217], a[172:175], v[178:181], v[214:217]
    v_mfma_f32_16x16x32_bf16 v[218:221], a[176:179], v[178:181], v[218:221]
    v_mfma_f32_16x16x32_bf16 v[222:225], a[180:183], v[178:181], v[222:225]
    v_mfma_f32_16x16x32_bf16 v[226:229], a[184:187], v[178:181], v[226:229]
    v_mfma_f32_16x16x32_bf16 v[230:233], a[188:191], v[178:181], v[230:233]
    s_waitcnt vmcnt(8)
    s_waitcnt lgkmcnt(0)
    s_add_u32 m0, s79, 12288
    s_nop 0
    buffer_load_dwordx4 v34, s[36:39], s84 offen nt lds
    s_add_u32 s84, s84, 4096
    s_and_b32 s84, s84, 0x1ffff
    s_add_u32 m0, s79, 13312
    s_nop 0
    buffer_load_dwordx4 v35, s[36:39], s84 offen nt lds
    s_add_u32 s84, s84, 4096
    s_and_b32 s84, s84, 0x1ffff
    s_add_u32 m0, s79, 14336
    s_nop 0
    buffer_load_dwordx4 v36, s[36:39], s84 offen nt lds
    s_add_u32 s84, s84, 4096
    s_and_b32 s84, s84, 0x1ffff
    s_add_u32 m0, s79, 15360
    s_nop 0
    buffer_load_dwordx4 v37, s[36:39], s84 offen nt lds
    s_add_u32 s84, s84, 4096
    s_and_b32 s84, s84, 0x1ffff
    v_readfirstlane_b32 s31, v51
    s_nop 0
    s_add_u32 s31, s31, 1
    v_and_b32 v191, 15, v1
    v_lshrrev_b32 v192, 4, v1
    s_mov_b32 s96, 0x40000000
    s_add_u32 s84, s79, 16384
    s_sub_u32 s78, s31, 0
    s_cmp_lt_u32 s78, 9
    s_cselect_b32 s75, 8, 1
    s_mul_i32 s75, s75, 1152
    v_lshrrev_b32 v193, 3, v1
    v_mul_lo_u32 v25, v193, s75
    v_and_b32 v193, 1, v192
    v_lshlrev_b32 v193, 1, v193
    v_and_b32 v198, 7, v1
    v_xor_b32 v193, v193, v198
    v_lshl_add_u32 v25, v193, 4, v25
    v_xor_b32 v26, 64, v25
    s_lshl_b32 s75, s75, 3
    s_cmp_lt_u32 s78, 9
    s_cbranch_scc1 LroleB
    s_mov_b32 s24, 2
    s_sub_u32 s78, s31, 27
    s_cmp_ge_u32 s31, 27
    s_cbranch_scc1 LroleF
    s_sub_u32 s78, s31, 9
    s_sub_u32 s98, s78, 4
    s_cmp_lt_u32 s98, 9
    s_cselect_b32 s24, 9, 1
    s_lshl_b32 s98, s98, 2
    s_add_u32 s98, s98, s80
    s_mul_i32 s91, s98, 6144
    s_add_u32 s91, s91, 1048576
    v_and_b32 v193, 3, v1
    v_lshl_add_u32 v193, v193, 2, v192
    v_lshrrev_b32 v194, 2, v191
    s_and_b32 s99, s98, 7
    s_cmp_eq_u32 s99, s81
    s_cselect_b32 s31, 1, 0
    s_lshl_b32 s99, s98, 5
    v_lshl_add_u32 v28, v193, 1, s99
    v_mul_u32_u24 v15, 1152, v194
    v_add_u32 v15, v15, v28
    s_lshr_b32 s99, s98, 1
    s_lshl_b32 s99, s99, 8
    s_and_b32 s100, s80, 1
    s_lshl_b32 s100, s100, 5
    s_add_u32 s99, s99, s100
    v_lshl_add_u32 v14, v193, 1, s99
    v_lshl_add_u32 v14, v194, 6, v14
    s_mov_b32 s36, s22
    s_mov_b32 s37, s23
    s_mov_b32 s38, 1152
    s_mov_b32 s39, 0x20000
    buffer_load_ushort v28, v28, s[36:39], 0 offen
    buffer_load_ushort v29, v15, s[64:67], 0 offen
    s_add_u32 s98, s78, 5
    s_cmp_lt_u32 s78, 4
    s_cselect_b32 s24, 3, s24
    s_cselect_b32 s91, s98, s91
    s_cmp_ge_u32 s78, 9
    s_cselect_b32 s99, 1, 0
    s_mul_i32 s100, s99, 9
    s_sub_u32 s78, s78, s100
    s_lshl_b32 s100, s99, 2
    s_add_u32 s100, s100, s80
    s_lshl_b32 s100, s100, 6
    s_mul_i32 s98, s81, 589824
    s_lshl_b32 s101, s78, 7
    s_add_u32 s98, s98, s101
    s_sub_u32 s46, 4718592, s98
    s_add_u32 s44, s12, s98
    s_addc_u32 s45, s13, 0
    s_mov_b32 s47, 0x20000
    s_mul_i32 s76, s100, s75
    s_lshr_b32 s76, s76, 3
    s_add_u32 m0, s79, 28672
    s_nop 0
    buffer_load_dwordx4 v25, s[44:47], s76 offen nt lds
    s_add_u32 s76, s76, s75
    s_add_u32 m0, s79, 29696
    s_nop 0
    buffer_load_dwordx4 v26, s[44:47], s76 offen nt lds
    s_add_u32 s76, s76, s75
    s_add_u32 m0, s79, 30720
    s_nop 0
    buffer_load_dwordx4 v25, s[44:47], s76 offen nt lds
    s_add_u32 s76, s76, s75
    s_add_u32 m0, s79, 31744
    s_nop 0
    buffer_load_dwordx4 v26, s[44:47], s76 offen nt lds
    s_add_u32 s76, s76, s75
    s_add_u32 m0, s79, 32768
    s_nop 0
    buffer_load_dwordx4 v25, s[44:47], s76 offen nt lds
    s_add_u32 s76, s76, s75
    s_add_u32 m0, s79, 33792
    s_nop 0
    buffer_load_dwordx4 v26, s[44:47], s76 offen nt lds
    s_add_u32 s76, s76, s75
    s_add_u32 m0, s79, 34816
    s_nop 0
    buffer_load_dwordx4 v25, s[44:47], s76 offen nt lds
    s_add_u32 s76, s76, s75
    s_add_u32 m0, s79, 35840
    s_nop 0
    buffer_load_dwordx4 v26, s[44:47], s76 offen nt lds
    s_add_u32 s76, s76, s75
    s_lshl_b32 s100, s99, 13
    v_add_u32 v11, s100, v11
    s_lshl_b32 s100, s99, 8
    v_add_u32 v12, s100, v12
    s_lshl_b32 s98, s78, 2
    s_add_u32 s98, s98, s80
    s_mul_i32 s98, s98, 6144
    s_lshl_b32 s101, s81, 9
    s_add_u32 s98, s98, s101
    s_add_u32 s98, s98, s100
    s_add_u32 s90, s98, 1048576
    s_mov_b32 s84, s79
    s_branch LroleE
LroleF:
    s_mov_b32 s91, s78
    s_mul_i32 s98, s81, 663552
    s_lshl_b32 s101, s78, 7
    s_add_u32 s98, s98, s101
    s_sub_u32 s46, 5308416, s98
    s_add_u32 s44, s20, s98
    s_addc_u32 s45, s21, 0
    s_mov_b32 s47, 0x20000
    s_mul_i32 s76, s3, s75
    s_lshr_b32 s76, s76, 3
    buffer_load_dword v52, off, s[48:51], s96
    buffer_load_dword v52, off, s[48:51], s96
    buffer_load_dword v52, off, s[48:51], s96
    buffer_load_dword v52, off, s[48:51], s96
    buffer_load_dword v52, off, s[48:51], s96
    buffer_load_dword v52, off, s[48:51], s96
    buffer_load_dword v52, off, s[48:51], s96
    buffer_load_dword v52, off, s[48:51], s96
    buffer_load_dword v52, off, s[48:51], s96
    buffer_load_dword v52, off, s[48:51], s96
    s_branch LroleE
LroleB:
    s_mov_b32 s24, 4
    s_mul_i32 s98, s81, 1152
    s_lshl_b32 s101, s78, 7
    s_add_u32 s98, s98, s101
    s_sub_u32 s46, 5308416, s98
    s_add_u32 s44, s16, s98
    s_addc_u32 s45, s17, 0
    s_mov_b32 s47, 0x20000
    s_mul_i32 s76, s3, s75
    s_lshr_b32 s76, s76, 3
    buffer_load_dword v52, off, s[48:51], s96
    buffer_load_dword v52, off, s[48:51], s96
    buffer_load_dword v52, off, s[48:51], s96
    buffer_load_dword v52, off, s[48:51], s96
    buffer_load_dword v52, off, s[48:51], s96
    buffer_load_dword v52, off, s[48:51], s96
    buffer_load_dword v52, off, s[48:51], s96
    buffer_load_dword v52, off, s[48:51], s96
    buffer_load_dword v52, off, s[48:51], s96
    buffer_load_dword v52, off, s[48:51], s96
    s_lshl_b32 s98, s78, 2
    s_add_u32 s98, s98, s80
    s_lshl_b32 s91, s81, 9
    s_add_u32 s91, s91, 1048576
    s_and_b32 s99, s98, 7
    s_cmp_eq_u32 s99, s81
    s_cselect_b32 s31, 1, 0
    s_lshl_b32 s99, s98, 5
    v_lshl_add_u32 v28, v191, 1, s99
    v_mul_u32_u24 v15, 1152, v192
    v_add_u32 v15, v15, v28
    s_lshr_b32 s99, s98, 1
    s_lshl_b32 s99, s99, 8
    s_and_b32 s100, s80, 1
    s_lshl_b32 s100, s100, 5
    s_add_u32 s99, s99, s100
    v_lshl_add_u32 v14, v191, 1, s99
    v_lshl_add_u32 v14, v192, 6, v14
    s_mul_i32 s100, s81, 1152
    s_add_u32 s32, s18, s100
    s_addc_u32 s33, s19, 0
    s_mov_b32 s34, 1152
    s_mov_b32 s35, 0x20000
LroleE:
    ds_read_b64_tr_b16 a[192:193], v42 offset:0
    ds_read_b64_tr_b16 a[196:197], v43 offset:0
    ds_read_b64_tr_b16 a[200:201], v44 offset:0
    ds_read_b64_tr_b16 a[204:205], v45 offset:0
    ds_read_b64_tr_b16 a[208:209], v46 offset:0
    ds_read_b64_tr_b16 a[212:213], v47 offset:0
    ds_read_b64_tr_b16 a[216:217], v48 offset:0
    ds_read_b64_tr_b16 a[220:221], v49 offset:0
    s_waitcnt vmcnt(18)
    ds_read_b64_tr_b16 a[194:195], v42 offset:4096
    ds_read_b64_tr_b16 a[198:199], v43 offset:4096
    ds_read_b64_tr_b16 a[202:203], v44 offset:4096
    ds_read_b64_tr_b16 a[206:207], v45 offset:4096
    ds_read_b64_tr_b16 a[210:211], v46 offset:4096
    ds_read_b64_tr_b16 a[214:215], v47 offset:4096
    ds_read_b64_tr_b16 a[218:219], v48 offset:4096
    ds_read_b64_tr_b16 a[222:223], v49 offset:4096
    s_waitcnt lgkmcnt(0)
    v_mfma_f32_16x16x32_bf16 v[202:205], a[192:195], v[182:185], v[202:205]
    v_mfma_f32_16x16x32_bf16 v[206:209], a[196:199], v[182:185], v[206:209]
    v_mfma_f32_16x16x32_bf16 v[210:213], a[200:203], v[182:185], v[210:213]
    v_mfma_f32_16x16x32_bf16 v[214:217], a[204:207], v[182:185], v[214:217]
    v_mfma_f32_16x16x32_bf16 v[218:221], a[208:211], v[182:185], v[218:221]
    v_mfma_f32_16x16x32_bf16 v[222:225], a[212:215], v[182:185], v[222:225]
    v_mfma_f32_16x16x32_bf16 v[226:229], a[216:219], v[182:185], v[226:229]
    v_mfma_f32_16x16x32_bf16 v[230:233], a[220:223], v[182:185], v[230:233]
    s_waitcnt vmcnt(14)
    ds_read_b64_tr_b16 a[224:225], v42 offset:8192
    ds_read_b64_tr_b16 a[228:229], v43 offset:8192
    ds_read_b64_tr_b16 a[232:233], v44 offset:8192
    ds_read_b64_tr_b16 a[236:237], v45 offset:8192
    ds_read_b64_tr_b16 a[240:241], v46 offset:8192
    ds_read_b64_tr_b16 a[244:245], v47 offset:8192
    ds_read_b64_tr_b16 a[248:249], v48 offset:8192
    ds_read_b64_tr_b16 a[252:253], v49 offset:8192
    s_waitcnt vmcnt(10)
    ds_read_b64_tr_b16 a[226:227], v42 offset:12288
    ds_read_b64_tr_b16 a[230:231], v43 offset:12288
    ds_read_b64_tr_b16 a[234:235], v44 offset:12288
    ds_read_b64_tr_b16 a[238:239], v45 offset:12288
    ds_read_b64_tr_b16 a[242:243], v46 offset:12288
    ds_read_b64_tr_b16 a[246:247], v47 offset:12288
    ds_read_b64_tr_b16 a[250:251], v48 offset:12288
    ds_read_b64_tr_b16 a[254:255], v49 offset:12288
    s_waitcnt lgkmcnt(0)
    s_mov_b32 exec_lo, 0x00030003
    s_mov_b32 exec_hi, 0x00030003
    v_mfma_f32_16x16x32_bf16 v[202:205], a[224:227], v[186:189], v[202:205]
    v_mfma_f32_16x16x32_bf16 v[206:209], a[228:231], v[186:189], v[206:209]
    v_mfma_f32_16x16x32_bf16 v[210:213], a[232:235], v[186:189], v[210:213]
    v_mfma_f32_16x16x32_bf16 v[214:217], a[236:239], v[186:189], v[214:217]
    s_nop 4
    ds_write_b128 v21, v[202:205] offset:0
    v_mfma_f32_16x16x32_bf16 v[218:221], a[240:243], v[186:189], v[218:221]
    ds_write_b128 v21, v[206:209] offset:64
    v_mfma_f32_16x16x32_bf16 v[222:225], a[244:247], v[186:189], v[222:225]
    ds_write_b128 v21, v[210:213] offset:128
    v_mfma_f32_16x16x32_bf16 v[226:229], a[248:251], v[186:189], v[226:229]
    ds_write_b128 v21, v[214:217] offset:192
    v_mfma_f32_16x16x32_bf16 v[230:233], a[252:255], v[186:189], v[230:233]
    s_nop 1
    ds_write_b128 v21, v[218:221] offset:256
    s_nop 0
    ds_write_b128 v21, v[222:225] offset:320
    s_nop 0
    ds_write_b128 v21, v[226:229] offset:384
    s_nop 0
    ds_write_b128 v21, v[230:233] offset:448
    s_mov_b64 exec, -1
    s_waitcnt lgkmcnt(0)
    s_barrier
    s_cmp_gt_u32 s80, 1
    s_cbranch_scc1 Laf9
    ds_read_b64 v[242:243], v22 offset:0
    ds_read_b64 v[244:245], v22 offset:1024
    ds_read_b64 v[246:247], v22 offset:2048
    ds_read_b64 v[248:249], v22 offset:3072
    s_waitcnt lgkmcnt(2)
    v_pk_add_f32 v[242:243], v[242:243], v[244:245]
    s_waitcnt lgkmcnt(0)
    v_pk_add_f32 v[246:247], v[246:247], v[248:249]
    v_pk_add_f32 v[242:243], v[242:243], v[246:247]
    v_cvt_pk_bf16_f32 v242, v242, v243
    buffer_store_dword v242, v10, s[52:55], s27 offen
    buffer_store_dword v242, v10, s[56:59], s27 offen sc1
    s_branch Laf10
Laf9:
    s_cmp_lg_u32 s80, 2
    s_cbranch_scc1 Laf10
    ds_read_b128 v[242:245], v24 offset:32
    s_mov_b64 exec, 3
    buffer_store_dword v240, v13, s[52:55], s28 offen
    buffer_store_dword v240, v13, s[56:59], s28 offen sc1
    s_waitcnt lgkmcnt(0)
    v_pk_add_f32 v[242:243], v[242:243], v[244:245]
    v_add_f32 v242, v242, v243
    buffer_store_dword v242, v13, s[52:55], s28 offen offset:16
    buffer_store_dword v242, v13, s[56:59], s28 offen offset:16 sc1
    s_mov_b64 exec, -1
Laf10:
    s_cmp_eq_u32 s24, 4
    s_cbranch_scc1 LlateB
    s_bitcmp0_b32 s24, 1
    s_cbranch_scc1 LTOP
    s_mov_b32 s78, s91
    s_lshl_b32 s98, s78, 2
    s_add_u32 s98, s98, s80
    s_mul_i32 s98, s98, 6144
    s_lshl_b32 s101, s81, 8
    s_add_u32 s98, s98, s101
    s_add_u32 s91, s98, 1052672
    s_cmp_eq_u32 s24, 2
    s_cbranch_scc1 LlateF2
    s_mul_i32 s98, s81, 663552
    s_lshl_b32 s101, s78, 7
    s_add_u32 s98, s98, s101
    s_sub_u32 s46, 5308416, s98
    s_add_u32 s44, s20, s98
    s_addc_u32 s45, s21, 0
    s_mov_b32 s47, 0x20000
    s_mul_i32 s76, s3, s75
    s_lshr_b32 s76, s76, 3
    s_branch LTOP
LlateF2:
    s_add_u32 m0, s84, 0
    s_nop 0
    buffer_load_dwordx4 v25, s[44:47], s76 offen nt lds
    s_add_u32 s76, s76, s75
    s_add_u32 m0, s84, 1024
    s_nop 0
    buffer_load_dwordx4 v26, s[44:47], s76 offen nt lds
    s_add_u32 s76, s76, s75
    s_add_u32 m0, s84, 2048
    s_nop 0
    buffer_load_dwordx4 v25, s[44:47], s76 offen nt lds
    s_add_u32 s76, s76, s75
    s_add_u32 m0, s84, 3072
    s_nop 0
    buffer_load_dwordx4 v26, s[44:47], s76 offen nt lds
    s_add_u32 s76, s76, s75
    s_add_u32 m0, s84, 4096
    s_nop 0
    buffer_load_dwordx4 v25, s[44:47], s76 offen nt lds
    s_add_u32 s76, s76, s75
    s_add_u32 m0, s84, 5120
    s_nop 0
    buffer_load_dwordx4 v26, s[44:47], s76 offen nt lds
    s_add_u32 s76, s76, s75
    s_add_u32 m0, s84, 6144
    s_nop 0
    buffer_load_dwordx4 v25, s[44:47], s76 offen nt lds
    s_add_u32 s76, s76, s75
    s_add_u32 m0, s84, 7168
    s_nop 0
    buffer_load_dwordx4 v26, s[44:47], s76 offen nt lds
    s_add_u32 s76, s76, s75
    s_add_u32 m0, s84, 8192
    s_nop 0
    buffer_load_dwordx4 v25, s[44:47], s76 offen nt lds
    s_add_u32 s76, s76, s75
    s_add_u32 m0, s84, 9216
    s_nop 0
    buffer_load_dwordx4 v26, s[44:47], s76 offen nt lds
    s_add_u32 s76, s76, s75
    s_add_u32 m0, s84, 10240
    s_nop 0
    buffer_load_dwordx4 v25, s[44:47], s76 offen nt lds
    s_add_u32 s76, s76, s75
    s_add_u32 m0, s84, 11264
    s_nop 0
    buffer_load_dwordx4 v26, s[44:47], s76 offen nt lds
    s_add_u32 s76, s76, s75
    s_add_u32 m0, s84, 12288
    s_nop 0
    buffer_load_dwordx4 v25, s[44:47], s76 offen nt lds
    s_add_u32 s76, s76, s75
    s_add_u32 m0, s84, 13312
    s_nop 0
    buffer_load_dwordx4 v26, s[44:47], s76 offen nt lds
    s_add_u32 s76, s76, s75
    s_add_u32 m0, s84, 14336
    s_nop 0
    buffer_load_dwordx4 v25, s[44:47], s76 offen nt lds
    s_add_u32 s76, s76, s75
    s_add_u32 m0, s84, 15360
    s_nop 0
    buffer_load_dwordx4 v26, s[44:47], s76 offen nt lds
    s_add_u32 s76, s76, s75
    s_add_u32 m0, s84, 16384
    s_add_u32 s76, s76, s77
    buffer_load_dwordx4 v25, s[44:47], s76 offen nt lds
    s_add_u32 s76, s76, s75
    s_add_u32 m0, s84, 17408
    s_nop 0
    buffer_load_dwordx4 v26, s[44:47], s76 offen nt lds
    s_add_u32 s76, s76, s75
    s_add_u32 m0, s84, 18432
    s_nop 0
    buffer_load_dwordx4 v25, s[44:47], s76 offen nt lds
    s_add_u32 s76, s76, s75
    s_add_u32 m0, s84, 19456
    s_nop 0
    buffer_load_dwordx4 v26, s[44:47], s76 offen nt lds
    s_add_u32 s76, s76, s75
    s_branch LTOP
LlateB:
    s_add_u32 m0, s84, 0
    s_nop 0
    buffer_load_dwordx4 v25, s[44:47], s76 offen nt lds
    s_add_u32 s76, s76, s75
    s_add_u32 m0, s84, 1024
    s_nop 0
    buffer_load_dwordx4 v26, s[44:47], s76 offen nt lds
    s_add_u32 s76, s76, s75
    s_add_u32 m0, s84, 2048
    s_nop 0
    buffer_load_dwordx4 v25, s[44:47], s76 offen nt lds
    s_add_u32 s76, s76, s75
    s_add_u32 m0, s84, 3072
    s_nop 0
    buffer_load_dwordx4 v26, s[44:47], s76 offen nt lds
    s_add_u32 s76, s76, s75
    s_add_u32 m0, s84, 4096
    s_nop 0
    buffer_load_dwordx4 v25, s[44:47], s76 offen nt lds
    s_add_u32 s76, s76, s75
    s_add_u32 m0, s84, 5120
    s_nop 0
    buffer_load_dwordx4 v26, s[44:47], s76 offen nt lds
    s_add_u32 s76, s76, s75
    s_add_u32 m0, s84, 6144
    s_nop 0
    buffer_load_dwordx4 v25, s[44:47], s76 offen nt lds
    s_add_u32 s76, s76, s75
    s_add_u32 m0, s84, 7168
    s_nop 0
    buffer_load_dwordx4 v26, s[44:47], s76 offen nt lds
    s_add_u32 s76, s76, s75
    s_add_u32 m0, s84, 8192
    s_nop 0
    buffer_load_dwordx4 v25, s[44:47], s76 offen nt lds
    s_add_u32 s76, s76, s75
    s_add_u32 m0, s84, 9216
    s_nop 0
    buffer_load_dwordx4 v26, s[44:47], s76 offen nt lds
    s_add_u32 s76, s76, s75
    s_add_u32 m0, s84, 10240
    s_nop 0
    buffer_load_dwordx4 v25, s[44:47], s76 offen nt lds
    s_add_u32 s76, s76, s75
    s_add_u32 m0, s84, 11264
    s_nop 0
    buffer_load_dwordx4 v26, s[44:47], s76 offen nt lds
    s_add_u32 s76, s76, s75
    s_add_u32 m0, s84, 12288
    s_nop 0
    buffer_load_dwordx4 v25, s[44:47], s76 offen nt lds
    s_add_u32 s76, s76, s75
    s_add_u32 m0, s84, 13312
    s_nop 0
    buffer_load_dwordx4 v26, s[44:47], s76 offen nt lds
    s_add_u32 s76, s76, s75
    s_add_u32 m0, s84, 14336
    s_nop 0
    buffer_load_dwordx4 v25, s[44:47], s76 offen nt lds
    s_add_u32 s76, s76, s75
    s_add_u32 m0, s84, 15360
    s_nop 0
    buffer_load_dwordx4 v26, s[44:47], s76 offen nt lds
    s_add_u32 s76, s76, s75
    s_add_u32 m0, s84, 16384
    s_add_u32 s76, s76, s77
    buffer_load_dwordx4 v25, s[44:47], s76 offen nt lds
    s_add_u32 s76, s76, s75
    s_add_u32 m0, s84, 17408
    s_nop 0
    buffer_load_dwordx4 v26, s[44:47], s76 offen nt lds
    s_add_u32 s76, s76, s75
    s_add_u32 m0, s84, 18432
    s_nop 0
    buffer_load_dwordx4 v25, s[44:47], s76 offen nt lds
    s_add_u32 s76, s76, s75
    s_add_u32 m0, s84, 19456
    s_nop 0
    buffer_load_dwordx4 v26, s[44:47], s76 offen nt lds
    s_add_u32 s76, s76, s75
    buffer_load_ushort v27, v28, s[32:35], 0 offen
LTOP:
LTOP2:
    s_cmp_eq_u32 s24, 2
    s_cbranch_scc1 LF2
    s_cmp_eq_u32 s24, 4
    s_cbranch_scc1 LB
    v_mov_b32 v174, -1
    v_mov_b32 v175, -1
    v_mov_b32 v176, -1
    v_mov_b32 v177, -1
    v_mov_b32 v178, -1
    v_mov_b32 v179, -1
    v_mov_b32 v180, -1
    v_mov_b32 v181, -1
    v_mov_b32 v218, -1
    v_mov_b32 v219, -1
    v_mov_b32 v220, -1
    v_mov_b32 v221, -1
    v_mov_b32 v222, -1
    v_mov_b32 v223, -1
    v_mov_b32 v224, -1
    v_mov_b32 v225, -1
    v_mov_b32 v106, -1
    v_mov_b32 v107, -1
    v_mov_b32 v108, -1
    v_mov_b32 v109, -1
    v_mov_b32 v110, -1
    v_mov_b32 v111, -1
    v_mov_b32 v112, -1
    v_mov_b32 v113, -1
    v_mov_b32 v114, -1
    v_mov_b32 v115, -1
    v_mov_b32 v116, -1
    v_mov_b32 v117, -1
    v_mov_b32 v118, -1
    v_mov_b32 v119, -1
    v_mov_b32 v120, -1
    v_mov_b32 v121, -1
    v_mov_b32 v122, -1
    v_mov_b32 v123, -1
    v_mov_b32 v124, -1
    v_mov_b32 v125, -1
    v_mov_b32 v126, -1
    v_mov_b32 v127, -1
    v_mov_b32 v128, -1
    v_mov_b32 v129, -1
    s_cmp_lg_u32 s85, 0
    s_cbranch_scc1 Lnp11
    buffer_load_dwordx4 v[174:177], v11, s[48:51], s88 offen sc1
    buffer_load_dwordx4 v[178:181], v11, s[48:51], s88 offen offset:1024 sc1
    buffer_load_dwordx4 v[218:221], v12, s[48:51], s89 offen sc1
    buffer_load_dwordx4 v[222:225], v12, s[48:51], s89 offen offset:16 sc1
    s_waitcnt vmcnt(4)
    v_lshlrev_b32 v28, 16, v28
    v_lshlrev_b32 v29, 16, v29
Lnp11:
    v_lshrrev_b32 v238, 4, v1
    v_bfe_u32 v239, v1, 2, 2
    v_lshl_add_u32 v239, v238, 3, v239
    v_lshl_add_u32 v239, v239, 7, s79
    v_and_b32 v240, 3, v1
    v_lshl_add_u32 v239, v240, 3, v239
    v_bfe_u32 v240, v1, 3, 2
    v_lshl_add_u32 v242, v240, 5, v239
    v_xor_b32 v243, 32, v242
    v_xor_b32 v244, 64, v242
    v_xor_b32 v245, 96, v242
    ds_read_b64_tr_b16 v[74:75], v242 offset:28672
    ds_read_b64_tr_b16 v[76:77], v242 offset:29184
    ds_read_b64_tr_b16 v[82:83], v243 offset:28672
    ds_read_b64_tr_b16 v[84:85], v243 offset:29184
    ds_read_b64_tr_b16 v[90:91], v244 offset:28672
    ds_read_b64_tr_b16 v[92:93], v244 offset:29184
    ds_read_b64_tr_b16 v[98:99], v245 offset:28672
    ds_read_b64_tr_b16 v[100:101], v245 offset:29184
    ds_read_b64_tr_b16 v[78:79], v242 offset:32768
    ds_read_b64_tr_b16 v[80:81], v242 offset:33280
    ds_read_b64_tr_b16 v[86:87], v243 offset:32768
    ds_read_b64_tr_b16 v[88:89], v243 offset:33280
    s_waitcnt lgkmcnt(4)
    ds_read_b64_tr_b16 v[94:95], v244 offset:32768
    ds_read_b64_tr_b16 v[96:97], v244 offset:33280
    ds_read_b64_tr_b16 v[102:103], v245 offset:32768
    ds_read_b64_tr_b16 v[104:105], v245 offset:33280
    s_waitcnt lgkmcnt(0)
Lo12:
    buffer_load_dwordx4 v[174:177], v11, s[48:51], s88 offen sc1
    buffer_load_dwordx4 v[178:181], v11, s[48:51], s88 offen offset:1024 sc1
    buffer_load_dwordx4 v[218:221], v12, s[48:51], s89 offen sc1
    buffer_load_dwordx4 v[222:225], v12, s[48:51], s89 offen offset:16 sc1
    s_waitcnt vmcnt(12)
    v_max3_u32 v251, v174, v178, v222
    v_max3_u32 v251, v251, v223, v224
    v_max_u32 v251, v251, v225
    v_cmp_eq_u32 vcc, -1, v251
    s_cbranch_vccz Lgo13
    s_nop 3
    v_max3_u32 v251, v174, v178, v222
    v_max3_u32 v251, v251, v223, v224
    v_max_u32 v251, v251, v225
    v_cmp_eq_u32 vcc, -1, v251
    s_cbranch_vccz Lgo13
    s_nop 3
    v_max3_u32 v251, v174, v178, v222
    v_max3_u32 v251, v251, v223, v224
    v_max_u32 v251, v251, v225
    v_cmp_eq_u32 vcc, -1, v251
    s_cbranch_vccz Lgo13
    s_nop 3
    v_max3_u32 v251, v174, v178, v222
    v_max3_u32 v251, v251, v223, v224
    v_max_u32 v251, v251, v225
    v_cmp_eq_u32 vcc, -1, v251
    s_cbranch_vccz Lgo13
    s_nop 3
    v_max3_u32 v251, v174, v178, v222
    v_max3_u32 v251, v251, v223, v224
    v_max_u32 v251, v251, v225
    v_cmp_eq_u32 vcc, -1, v251
    s_cbranch_vccz Lgo13
    s_nop 3
    s_sub_u32 s83, s83, 1
    s_cbranch_scc0 Lo12
    s_mov_b32 s83, 0
Lgo13:
    v_mfma_f32_16x16x32_bf16 v[202:205], v[174:177], v[74:77], 0
    v_max3_f32 v238, v218, v219, v220
    v_max_f32 v238, v238, v221
    v_mfma_f32_16x16x32_bf16 v[202:205], v[178:181], v[78:81], v[202:205]
    v_sub_f32 v226, v218, v238
    v_sub_f32 v227, v219, v238
    v_mfma_f32_16x16x32_bf16 v[206:209], v[174:177], v[82:85], 0
    v_sub_f32 v228, v220, v238
    v_sub_f32 v229, v221, v238
    v_mfma_f32_16x16x32_bf16 v[206:209], v[178:181], v[86:89], v[206:209]
    v_exp_f32 v226, v226
    v_exp_f32 v227, v227
    v_mfma_f32_16x16x32_bf16 v[210:213], v[174:177], v[90:93], 0
    v_exp_f32 v228, v228
    v_exp_f32 v229, v229
    v_mfma_f32_16x16x32_bf16 v[210:213], v[178:181], v[94:97], v[210:213]
    v_pk_mul_f32 v[240:241], v[222:223], v[226:227]
    v_pk_fma_f32 v[240:241], v[224:225], v[228:229], v[240:241]
    v_mfma_f32_16x16x32_bf16 v[214:217], v[174:177], v[98:101], 0
    v_add_f32 v238, v240, v241
    v_rcp_f32 v238, v238
    v_mfma_f32_16x16x32_bf16 v[214:217], v[178:181], v[102:105], v[214:217]
    s_nop 0
    v_pk_mul_f32 v[226:227], v[226:227], v[238:239] op_sel_hi:[1,0]
    v_pk_mul_f32 v[228:229], v[228:229], v[238:239] op_sel_hi:[1,0]
    v_pk_mul_f32 v[202:203], v[202:203], v[226:227]
    v_pk_fma_f32 v[202:203], v[204:205], v[228:229], v[202:203]
    v_add_f32 v202, v202, v203
    v_cmp_u_f32 vcc, v202, v202
    s_cbranch_vccz Lok14
    s_sub_u32 s83, s83, 1
    s_cbranch_scc0 Lo12
    s_mov_b32 s83, 0
Lok14:
    ds_write_b32 v17, v202 offset:0
    v_pk_mul_f32 v[206:207], v[206:207], v[226:227]
    v_pk_fma_f32 v[206:207], v[208:209], v[228:229], v[206:207]
    v_add_f32 v206, v206, v207
    ds_write_b32 v17, v206 offset:320
    v_pk_mul_f32 v[210:211], v[210:211], v[226:227]
    v_pk_fma_f32 v[210:211], v[212:213], v[228:229], v[210:211]
    v_add_f32 v210, v210, v211
    ds_write_b32 v17, v210 offset:640
    v_pk_mul_f32 v[214:215], v[214:215], v[226:227]
    v_pk_fma_f32 v[214:215], v[216:217], v[228:229], v[214:215]
    v_add_f32 v214, v214, v215
    ds_write_b32 v17, v214 offset:960
    s_waitcnt lgkmcnt(0)
    s_barrier
    ds_read2st64_b32 v[238:239], v18 offset0:0 offset1:5
    ds_read2st64_b32 v[240:241], v18 offset0:10 offset1:15
    s_waitcnt lgkmcnt(0)
    v_pk_add_f32 v[238:239], v[238:239], v[240:241]
    v_add_f32 v238, v238, v239
    buffer_store_dword v238, v2, s[48:51], s90 offen sc1
    s_cmp_eq_u32 s24, 9
    s_cbranch_scc1 LR
    s_cmp_eq_u32 s24, 1
    s_cbranch_scc1 LIDLE
    s_cmp_lg_u32 s85, 0
    s_cbranch_scc1 Lnp15
    s_add_u32 m0, s84, 0
    s_nop 0
    buffer_load_dwordx4 v25, s[44:47], s76 offen nt lds
    s_add_u32 s76, s76, s75
    s_add_u32 m0, s84, 1024
    s_nop 0
    buffer_load_dwordx4 v26, s[44:47], s76 offen nt lds
    s_add_u32 s76, s76, s75
    s_add_u32 m0, s84, 2048
    s_nop 0
    buffer_load_dwordx4 v25, s[44:47], s76 offen nt lds
    s_add_u32 s76, s76, s75
    s_add_u32 m0, s84, 3072
    s_nop 0
    buffer_load_dwordx4 v26, s[44:47], s76 offen nt lds
    s_add_u32 s76, s76, s75
    s_add_u32 m0, s84, 4096
    s_nop 0
    buffer_load_dwordx4 v25, s[44:47], s76 offen nt lds
    s_add_u32 s76, s76, s75
    s_add_u32 m0, s84, 5120
    s_nop 0
    buffer_load_dwordx4 v26, s[44:47], s76 offen nt lds
    s_add_u32 s76, s76, s75
    s_add_u32 m0, s84, 6144
    s_nop 0
    buffer_load_dwordx4 v25, s[44:47], s76 offen nt lds
    s_add_u32 s76, s76, s75
    s_add_u32 m0, s84, 7168
    s_nop 0
    buffer_load_dwordx4 v26, s[44:47], s76 offen nt lds
    s_add_u32 s76, s76, s75
    s_add_u32 m0, s84, 8192
    s_nop 0
    buffer_load_dwordx4 v25, s[44:47], s76 offen nt lds
    s_add_u32 s76, s76, s75
    s_add_u32 m0, s84, 9216
    s_nop 0
    buffer_load_dwordx4 v26, s[44:47], s76 offen nt lds
    s_add_u32 s76, s76, s75
    s_add_u32 m0, s84, 10240
    s_nop 0
    buffer_load_dwordx4 v25, s[44:47], s76 offen nt lds
    s_add_u32 s76, s76, s75
    s_add_u32 m0, s84, 11264
    s_nop 0
    buffer_load_dwordx4 v26, s[44:47], s76 offen nt lds
    s_add_u32 s76, s76, s75
    s_add_u32 m0, s84, 12288
    s_nop 0
    buffer_load_dwordx4 v25, s[44:47], s76 offen nt lds
    s_add_u32 s76, s76, s75
    s_add_u32 m0, s84, 13312
    s_nop 0
    buffer_load_dwordx4 v26, s[44:47], s76 offen nt lds
    s_add_u32 s76, s76, s75
    s_add_u32 m0, s84, 14336
    s_nop 0
    buffer_load_dwordx4 v25, s[44:47], s76 offen nt lds
    s_add_u32 s76, s76, s75
    s_add_u32 m0, s84, 15360
    s_nop 0
    buffer_load_dwordx4 v26, s[44:47], s76 offen nt lds
    s_add_u32 s76, s76, s75
    s_add_u32 m0, s84, 16384
    s_add_u32 s76, s76, s77
    buffer_load_dwordx4 v25, s[44:47], s76 offen nt lds
    s_add_u32 s76, s76, s75
    s_add_u32 m0, s84, 17408
    s_nop 0
    buffer_load_dwordx4 v26, s[44:47], s76 offen nt lds
    s_add_u32 s76, s76, s75
    s_add_u32 m0, s84, 18432
    s_nop 0
    buffer_load_dwordx4 v25, s[44:47], s76 offen nt lds
    s_add_u32 s76, s76, s75
    s_add_u32 m0, s84, 19456
    s_nop 0
    buffer_load_dwordx4 v26, s[44:47], s76 offen nt lds
    s_add_u32 s76, s76, s75
Lnp15:
    s_branch LF2
LIDLE:
    s_cmp_lg_u32 s85, 0
    s_cbranch_scc1 LFIN
Lg16:
    buffer_load_dword v238, off, s[48:51], s93 sc1
    s_waitcnt vmcnt(0)
    v_cmp_eq_u32 vcc, -1, v238
    s_cbranch_vccz Lok17
    s_sub_u32 s83, s83, 1
    s_cbranch_scc0 Lg16
    s_mov_b32 s83, 0
Lok17:
    s_branch LQ2P
LF2:
    s_mov_b64 exec, s[94:95]
    v_mov_b32 v154, -1
    v_mov_b32 v155, -1
    v_mov_b32 v156, -1
    v_mov_b32 v157, -1
    v_mov_b32 v158, -1
    v_mov_b32 v159, -1
    v_mov_b32 v160, -1
    v_mov_b32 v161, -1
    v_mov_b32 v162, -1
    v_mov_b32 v163, -1
    v_mov_b32 v164, -1
    v_mov_b32 v165, -1
    v_mov_b32 v166, -1
    v_mov_b32 v167, -1
    v_mov_b32 v168, -1
    v_mov_b32 v169, -1
    v_mov_b32 v170, -1
    v_mov_b32 v171, -1
    v_mov_b32 v172, -1
    v_mov_b32 v173, -1
    s_mov_b64 exec, -1
    v_lshrrev_b32 v238, 4, v1
    v_bfe_u32 v239, v1, 2, 2
    v_lshl_add_u32 v239, v238, 3, v239
    v_lshl_add_u32 v239, v239, 7, s84
    v_and_b32 v240, 3, v1
    v_lshl_add_u32 v239, v240, 3, v239
    v_bfe_u32 v240, v1, 3, 2
    v_lshl_add_u32 v242, v240, 5, v239
    v_xor_b32 v243, 32, v242
    v_xor_b32 v244, 64, v242
    v_xor_b32 v245, 96, v242
    s_waitcnt vmcnt(0)
    ds_read_b64_tr_b16 v[74:75], v242 offset:0
    ds_read_b64_tr_b16 v[76:77], v242 offset:512
    ds_read_b64_tr_b16 v[94:95], v243 offset:0
    ds_read_b64_tr_b16 v[96:97], v243 offset:512
    ds_read_b64_tr_b16 v[114:115], v244 offset:0
    ds_read_b64_tr_b16 v[116:117], v244 offset:512
    ds_read_b64_tr_b16 v[134:135], v245 offset:0
    ds_read_b64_tr_b16 v[136:137], v245 offset:512
    ds_read_b64_tr_b16 v[78:79], v242 offset:4096
    ds_read_b64_tr_b16 v[80:81], v242 offset:4608
    ds_read_b64_tr_b16 v[98:99], v243 offset:4096
    ds_read_b64_tr_b16 v[100:101], v243 offset:4608
    s_waitcnt lgkmcnt(4)
    ds_read_b64_tr_b16 v[118:119], v244 offset:4096
    ds_read_b64_tr_b16 v[120:121], v244 offset:4608
    ds_read_b64_tr_b16 v[138:139], v245 offset:4096
    ds_read_b64_tr_b16 v[140:141], v245 offset:4608
    ds_read_b64_tr_b16 v[82:83], v242 offset:8192
    ds_read_b64_tr_b16 v[84:85], v242 offset:8704
    ds_read_b64_tr_b16 v[102:103], v243 offset:8192
    ds_read_b64_tr_b16 v[104:105], v243 offset:8704
    ds_read_b64_tr_b16 v[122:123], v244 offset:8192
    ds_read_b64_tr_b16 v[124:125], v244 offset:8704
    ds_read_b64_tr_b16 v[142:143], v245 offset:8192
    ds_read_b64_tr_b16 v[144:145], v245 offset:8704
    s_waitcnt lgkmcnt(4)
    ds_read_b64_tr_b16 v[86:87], v242 offset:12288
    ds_read_b64_tr_b16 v[88:89], v242 offset:12800
    ds_read_b64_tr_b16 v[106:107], v243 offset:12288
    ds_read_b64_tr_b16 v[108:109], v243 offset:12800
    ds_read_b64_tr_b16 v[126:127], v244 offset:12288
    ds_read_b64_tr_b16 v[128:129], v244 offset:12800
    ds_read_b64_tr_b16 v[146:147], v245 offset:12288
    ds_read_b64_tr_b16 v[148:149], v245 offset:12800
    ds_read_b64_tr_b16 v[90:91], v242 offset:16384
    ds_read_b64_tr_b16 v[92:93], v242 offset:16896
    ds_read_b64_tr_b16 v[110:111], v243 offset:16384
    ds_read_b64_tr_b16 v[112:113], v243 offset:16896
    s_waitcnt lgkmcnt(4)
    ds_read_b64_tr_b16 v[130:131], v244 offset:16384
    ds_read_b64_tr_b16 v[132:133], v244 offset:16896
    ds_read_b64_tr_b16 v[150:151], v245 offset:16384
    ds_read_b64_tr_b16 v[152:153], v245 offset:16896
    s_waitcnt lgkmcnt(0)
Lg18:
    buffer_load_dword v238, off, s[48:51], s92 sc1
    s_waitcnt vmcnt(0)
    v_cmp_eq_u32 vcc, -1, v238
    s_cbranch_vccz Lok19
    s_sub_u32 s83, s83, 1
    s_cbranch_scc0 Lg18
    s_mov_b32 s83, 0
Lok19:
    s_add_u32 s101, s93, s77
Lf220:
    s_mov_b64 exec, s[94:95]
    buffer_load_dwordx4 v[154:157], v3, s[48:51], s93 offen sc1
    buffer_load_dwordx4 v[158:161], v3, s[48:51], s93 offen offset:256 sc1
    buffer_load_dwordx4 v[162:165], v3, s[48:51], s93 offen offset:512 sc1
    buffer_load_dwordx4 v[166:169], v3, s[48:51], s93 offen offset:768 sc1
    buffer_load_dwordx4 v[170:173], v3, s[48:51], s101 offen offset:1024 sc1
    s_mov_b64 exec, -1
    s_waitcnt vmcnt(15)
    v_max3_u32 v251, v154, v158, v162
    v_max3_u32 v251, v251, v166, v170
    v_cmp_eq_u32 vcc, -1, v251
    s_cbranch_vccz Lgo21
    s_nop 3
    v_max3_u32 v251, v154, v158, v162
    v_max3_u32 v251, v251, v166, v170
    v_cmp_eq_u32 vcc, -1, v251
    s_cbranch_vccz Lgo21
    s_nop 3
    v_max3_u32 v251, v154, v158, v162
    v_max3_u32 v251, v251, v166, v170
    v_cmp_eq_u32 vcc, -1, v251
    s_cbranch_vccz Lgo21
    s_nop 3
    v_max3_u32 v251, v154, v158, v162
    v_max3_u32 v251, v251, v166, v170
    v_cmp_eq_u32 vcc, -1, v251
    s_cbranch_vccz Lgo21
    s_nop 3
    v_max3_u32 v251, v154, v158, v162
    v_max3_u32 v251, v251, v166, v170
    v_cmp_eq_u32 vcc, -1, v251
    s_cbranch_vccz Lgo21
    s_nop 3
    v_max3_u32 v251, v154, v158, v162
    v_max3_u32 v251, v251, v166, v170
    v_cmp_eq_u32 vcc, -1, v251
    s_cbranch_vccz Lgo21
    s_nop 3
    v_max3_u32 v251, v154, v158, v162
    v_max3_u32 v251, v251, v166, v170
    v_cmp_eq_u32 vcc, -1, v251
    s_cbranch_vccz Lgo21
    s_nop 3
    v_max3_u32 v251, v154, v158, v162
    v_max3_u32 v251, v251, v166, v170
    v_cmp_eq_u32 vcc, -1, v251
    s_cbranch_vccz Lgo21
    s_nop 3
    s_sub_u32 s83, s83, 1
    s_cbranch_scc0 Lf220
    s_mov_b32 s83, 0
Lgo21:
    v_mfma_f32_16x16x32_bf16 v[202:205], v[74:77], v[154:157], 0
    v_mfma_f32_16x16x32_bf16 v[202:205], v[78:81], v[158:161], v[202:205]
    v_mfma_f32_16x16x32_bf16 v[202:205], v[82:85], v[162:165], v[202:205]
    v_mfma_f32_16x16x32_bf16 v[202:205], v[86:89], v[166:169], v[202:205]
    v_mfma_f32_16x16x32_bf16 v[202:205], v[90:93], v[170:173], v[202:205]
    v_mfma_f32_16x16x32_bf16 v[206:209], v[94:97], v[154:157], 0
    v_mfma_f32_16x16x32_bf16 v[206:209], v[98:101], v[158:161], v[206:209]
    v_mfma_f32_16x16x32_bf16 v[206:209], v[102:105], v[162:165], v[206:209]
    v_mfma_f32_16x16x32_bf16 v[206:209], v[106:109], v[166:169], v[206:209]
    v_mfma_f32_16x16x32_bf16 v[206:209], v[110:113], v[170:173], v[206:209]
    v_mfma_f32_16x16x32_bf16 v[210:213], v[114:117], v[154:157], 0
    v_mfma_f32_16x16x32_bf16 v[210:213], v[118:121], v[158:161], v[210:213]
    v_mfma_f32_16x16x32_bf16 v[210:213], v[122:125], v[162:165], v[210:213]
    v_cmp_u_f32 vcc, v202, v202
    s_cbranch_vccz Lok22
    s_sub_u32 s83, s83, 1
    s_cbranch_scc0 Lf220
    s_mov_b32 s83, 0
Lok22:
    v_mfma_f32_16x16x32_bf16 v[210:213], v[126:129], v[166:169], v[210:213]
    s_mov_b64 exec, s[94:95]
    ds_write_b128 v16, v[202:205] offset:0
    s_mov_b64 exec, -1
    v_mfma_f32_16x16x32_bf16 v[210:213], v[130:133], v[170:173], v[210:213]
    s_mov_b64 exec, s[94:95]
    ds_write_b128 v16, v[206:209] offset:320
    s_mov_b64 exec, -1
    v_mfma_f32_16x16x32_bf16 v[214:217], v[134:137], v[154:157], 0
    v_mfma_f32_16x16x32_bf16 v[214:217], v[138:141], v[158:161], v[214:217]
    v_mfma_f32_16x16x32_bf16 v[214:217], v[142:145], v[162:165], v[214:217]
    v_mfma_f32_16x16x32_bf16 v[214:217], v[146:149], v[166:169], v[214:217]
    v_mfma_f32_16x16x32_bf16 v[214:217], v[150:153], v[170:173], v[214:217]
    s_mov_b64 exec, s[94:95]
    ds_write_b128 v16, v[210:213] offset:640
    s_mov_b64 exec, -1
    s_mov_b64 exec, s[94:95]
    s_nop 3
    ds_write_b128 v16, v[214:217] offset:960
    s_mov_b64 exec, -1
    s_waitcnt lgkmcnt(0)
    s_barrier
    ds_read2st64_b32 v[238:239], v18 offset0:0 offset1:5
    ds_read2st64_b32 v[240:241], v18 offset0:10 offset1:15
    s_waitcnt lgkmcnt(0)
    v_pk_add_f32 v[238:239], v[238:239], v[240:241]
    v_add_f32 v238, v238, v239
    buffer_store_dword v238, v2, s[48:51], s91 offen sc1
    s_cmp_lg_u32 s85, 0
    s_cbranch_scc1 LFIN
    s_branch LQ2P
LB:
    s_mov_b64 exec, s[94:95]
    v_mov_b32 v154, -1
    v_mov_b32 v155, -1
    v_mov_b32 v156, -1
    v_mov_b32 v157, -1
    v_mov_b32 v158, -1
    v_mov_b32 v159, -1
    v_mov_b32 v160, -1
    v_mov_b32 v161, -1
    v_mov_b32 v162, -1
    v_mov_b32 v163, -1
    v_mov_b32 v164, -1
    v_mov_b32 v165, -1
    v_mov_b32 v166, -1
    v_mov_b32 v167, -1
    v_mov_b32 v168, -1
    v_mov_b32 v169, -1
    v_mov_b32 v170, -1
    v_mov_b32 v171, -1
    v_mov_b32 v172, -1
    v_mov_b32 v173, -1
    s_mov_b64 exec, -1
    s_cmp_lg_u32 s85, 0
    s_cbranch_scc1 Lnp23
    s_waitcnt vmcnt(0)
    v_lshrrev_b32 v238, 4, v1
    v_bfe_u32 v239, v1, 2, 2
    v_lshl_add_u32 v239, v238, 3, v239
    v_lshl_add_u32 v239, v239, 7, s84
    v_and_b32 v240, 3, v1
    v_lshl_add_u32 v239, v240, 3, v239
    v_bfe_u32 v240, v1, 3, 2
    v_lshl_add_u32 v242, v240, 5, v239
    v_xor_b32 v243, 32, v242
    v_xor_b32 v244, 64, v242
    v_xor_b32 v245, 96, v242
    ds_read_b64_tr_b16 v[74:75], v242 offset:0
    ds_read_b64_tr_b16 v[76:77], v242 offset:512
    ds_read_b64_tr_b16 v[94:95], v243 offset:0
    ds_read_b64_tr_b16 v[96:97], v243 offset:512
    ds_read_b64_tr_b16 v[114:115], v244 offset:0
    ds_read_b64_tr_b16 v[116:117], v244 offset:512
    ds_read_b64_tr_b16 v[134:135], v245 offset:0
    ds_read_b64_tr_b16 v[136:137], v245 offset:512
    ds_read_b64_tr_b16 v[78:79], v242 offset:4096
    ds_read_b64_tr_b16 v[80:81], v242 offset:4608
    ds_read_b64_tr_b16 v[98:99], v243 offset:4096
    ds_read_b64_tr_b16 v[100:101], v243 offset:4608
    s_waitcnt lgkmcnt(4)
    ds_read_b64_tr_b16 v[118:119], v244 offset:4096
    ds_read_b64_tr_b16 v[120:121], v244 offset:4608
    ds_read_b64_tr_b16 v[138:139], v245 offset:4096
    ds_read_b64_tr_b16 v[140:141], v245 offset:4608
    ds_read_b64_tr_b16 v[82:83], v242 offset:8192
    ds_read_b64_tr_b16 v[84:85], v242 offset:8704
    ds_read_b64_tr_b16 v[102:103], v243 offset:8192
    ds_read_b64_tr_b16 v[104:105], v243 offset:8704
    ds_read_b64_tr_b16 v[122:123], v244 offset:8192
    ds_read_b64_tr_b16 v[124:125], v244 offset:8704
    ds_read_b64_tr_b16 v[142:143], v245 offset:8192
    ds_read_b64_tr_b16 v[144:145], v245 offset:8704
    s_waitcnt lgkmcnt(4)
    ds_read_b64_tr_b16 v[86:87], v242 offset:12288
    ds_read_b64_tr_b16 v[88:89], v242 offset:12800
    ds_read_b64_tr_b16 v[106:107], v243 offset:12288
    ds_read_b64_tr_b16 v[108:109], v243 offset:12800
    ds_read_b64_tr_b16 v[126:127], v244 offset:12288
    ds_read_b64_tr_b16 v[128:129], v244 offset:12800
    ds_read_b64_tr_b16 v[146:147], v245 offset:12288
    ds_read_b64_tr_b16 v[148:149], v245 offset:12800
    ds_read_b64_tr_b16 v[90:91], v242 offset:16384
    ds_read_b64_tr_b16 v[92:93], v242 offset:16896
    ds_read_b64_tr_b16 v[110:111], v243 offset:16384
    ds_read_b64_tr_b16 v[112:113], v243 offset:16896
    s_waitcnt lgkmcnt(4)
    ds_read_b64_tr_b16 v[130:131], v244 offset:16384
    ds_read_b64_tr_b16 v[132:133], v244 offset:16896
    ds_read_b64_tr_b16 v[150:151], v245 offset:16384
    ds_read_b64_tr_b16 v[152:153], v245 offset:16896
    s_waitcnt lgkmcnt(0)
    v_lshlrev_b32 v27, 16, v27
Lnp23:
Lg24:
    buffer_load_dword v238, off, s[48:51], s91 sc1
    s_waitcnt vmcnt(0)
    v_cmp_eq_u32 vcc, -1, v238
    s_cbranch_vccz Lok25
    s_sub_u32 s83, s83, 1
    s_cbranch_scc0 Lg24
    s_mov_b32 s83, 0
Lok25:
    s_add_u32 s101, s92, s77
Lf126:
    s_mov_b64 exec, s[94:95]
    buffer_load_dwordx4 v[154:157], v3, s[48:51], s92 offen sc1
    buffer_load_dwordx4 v[158:161], v3, s[48:51], s92 offen offset:256 sc1
    buffer_load_dwordx4 v[162:165], v3, s[48:51], s92 offen offset:512 sc1
    buffer_load_dwordx4 v[166:169], v3, s[48:51], s92 offen offset:768 sc1
    buffer_load_dwordx4 v[170:173], v3, s[48:51], s101 offen offset:1024 sc1
    s_mov_b64 exec, -1
    s_waitcnt vmcnt(15)
    v_max3_u32 v251, v154, v158, v162
    v_max3_u32 v251, v251, v166, v170
    v_cmp_eq_u32 vcc, -1, v251
    s_cbranch_vccz Lgo27
    s_nop 3
    v_max3_u32 v251, v154, v158, v162
    v_max3_u32 v251, v251, v166, v170
    v_cmp_eq_u32 vcc, -1, v251
    s_cbranch_vccz Lgo27
    s_nop 3
    v_max3_u32 v251, v154, v158, v162
    v_max3_u32 v251, v251, v166, v170
    v_cmp_eq_u32 vcc, -1, v251
    s_cbranch_vccz Lgo27
    s_nop 3
    v_max3_u32 v251, v154, v158, v162
    v_max3_u32 v251, v251, v166, v170
    v_cmp_eq_u32 vcc, -1, v251
    s_cbranch_vccz Lgo27
    s_nop 3
    v_max3_u32 v251, v154, v158, v162
    v_max3_u32 v251, v251, v166, v170
    v_cmp_eq_u32 vcc, -1, v251
    s_cbranch_vccz Lgo27
    s_nop 3
    v_max3_u32 v251, v154, v158, v162
    v_max3_u32 v251, v251, v166, v170
    v_cmp_eq_u32 vcc, -1, v251
    s_cbranch_vccz Lgo27
    s_nop 3
    v_max3_u32 v251, v154, v158, v162
    v_max3_u32 v251, v251, v166, v170
    v_cmp_eq_u32 vcc, -1, v251
    s_cbranch_vccz Lgo27
    s_nop 3
    v_max3_u32 v251, v154, v158, v162
    v_max3_u32 v251, v251, v166, v170
    v_cmp_eq_u32 vcc, -1, v251
    s_cbranch_vccz Lgo27
    s_nop 3
    s_sub_u32 s83, s83, 1
    s_cbranch_scc0 Lf126
    s_mov_b32 s83, 0
Lgo27:
    v_mfma_f32_16x16x32_bf16 v[202:205], v[154:157], v[154:157], 0
    v_mfma_f32_16x16x32_bf16 v[202:205], v[158:161], v[158:161], v[202:205]
    v_mfma_f32_16x16x32_bf16 v[202:205], v[162:165], v[162:165], v[202:205]
    v_mfma_f32_16x16x32_bf16 v[202:205], v[166:169], v[166:169], v[202:205]
    v_mfma_f32_16x16x32_bf16 v[202:205], v[170:173], v[170:173], v[202:205]
    v_mfma_f32_16x16x32_bf16 v[206:209], v[74:77], v[154:157], 0
    v_mfma_f32_16x16x32_bf16 v[206:209], v[78:81], v[158:161], v[206:209]
    v_mfma_f32_16x16x32_bf16 v[206:209], v[82:85], v[162:165], v[206:209]
    v_mfma_f32_16x16x32_bf16 v[206:209], v[86:89], v[166:169], v[206:209]
    v_mfma_f32_16x16x32_bf16 v[206:209], v[90:93], v[170:173], v[206:209]
    v_mfma_f32_16x16x32_bf16 v[210:213], v[94:97], v[154:157], 0
    v_mfma_f32_16x16x32_bf16 v[210:213], v[98:101], v[158:161], v[210:213]
    v_mfma_f32_16x16x32_bf16 v[210:213], v[102:105], v[162:165], v[210:213]
    v_cmp_u_f32 vcc, v202, v202
    s_cbranch_vccz Lok28
    s_sub_u32 s83, s83, 1
    s_cbranch_scc0 Lf126
    s_mov_b32 s83, 0
Lok28:
    v_mfma_f32_16x16x32_bf16 v[210:213], v[106:109], v[166:169], v[210:213]
    s_mov_b64 s[96:97], 2
    v_cndmask_b32 v202, v202, v203, s[96:97]
    v_mfma_f32_16x16x32_bf16 v[210:213], v[110:113], v[170:173], v[210:213]
    s_mov_b64 s[96:97], 4
    v_cndmask_b32 v202, v202, v204, s[96:97]
    v_mfma_f32_16x16x32_bf16 v[214:217], v[114:117], v[154:157], 0
    s_mov_b64 s[96:97], 8
    v_cndmask_b32 v202, v202, v205, s[96:97]
    v_mfma_f32_16x16x32_bf16 v[214:217], v[118:121], v[158:161], v[214:217]
    ds_write_b32 v19, v202
    v_mfma_f32_16x16x32_bf16 v[214:217], v[122:125], v[162:165], v[214:217]
    s_mov_b32 exec_lo, 0x001f001f
    s_mov_b32 exec_hi, 0x001f001f
    ds_write_b128 v16, v[206:209] offset:0
    s_mov_b64 exec, -1
    v_mfma_f32_16x16x32_bf16 v[214:217], v[126:129], v[166:169], v[214:217]
    v_mfma_f32_16x16x32_bf16 v[214:217], v[130:133], v[170:173], v[214:217]
    v_mfma_f32_16x16x32_bf16 v[218:221], v[134:137], v[154:157], 0
    v_mfma_f32_16x16x32_bf16 v[218:221], v[138:141], v[158:161], v[218:221]
    v_mfma_f32_16x16x32_bf16 v[218:221], v[142:145], v[162:165], v[218:221]
    s_mov_b32 exec_lo, 0x001f001f
    s_mov_b32 exec_hi, 0x001f001f
    ds_write_b128 v16, v[210:213] offset:320
    s_mov_b64 exec, -1
    v_mfma_f32_16x16x32_bf16 v[218:221], v[146:149], v[166:169], v[218:221]
    v_mfma_f32_16x16x32_bf16 v[218:221], v[150:153], v[170:173], v[218:221]
    s_mov_b32 exec_lo, 0x001f001f
    s_mov_b32 exec_hi, 0x001f001f
    ds_write_b128 v16, v[214:217] offset:640
    s_nop 4
    ds_write_b128 v16, v[218:221] offset:960
    s_mov_b64 exec, -1
    s_waitcnt lgkmcnt(0)
    s_barrier
    ds_read_b128 v[242:245], v20
    ds_read_b128 v[246:249], v20 offset:16
    ds_read2st64_b32 v[234:235], v31 offset0:0 offset1:5
    ds_read2st64_b32 v[236:237], v31 offset0:10 offset1:15
    ds_read2st64_b32 v[238:239], v18 offset0:0 offset1:5
    ds_read2st64_b32 v[240:241], v18 offset0:10 offset1:15
    s_waitcnt lgkmcnt(4)
    v_pk_add_f32 v[242:243], v[242:243], v[244:245]
    v_pk_add_f32 v[246:247], v[246:247], v[248:249]
    v_pk_add_f32 v[242:243], v[242:243], v[246:247]
    v_mul_f32 v242, s29, v242
    v_mov_b32 v244, s30
    v_fma_f32 v243, v243, s29, v244
    v_fma_f32 v243, -v242, v242, v243
    v_rsq_f32 v243, v243
    s_waitcnt lgkmcnt(2)
    v_pk_add_f32 v[234:235], v[234:235], v[236:237]
    v_add_f32 v234, v234, v235
    s_waitcnt lgkmcnt(0)
    v_pk_add_f32 v[238:239], v[238:239], v[240:241]
    v_add_f32 v238, v238, v239
    v_fma_f32 v238, -v242, v234, v238
    v_fma_f32 v238, v238, v243, v27
    v_mov_b32 v240, 0xc0135761
    v_mul_f32 v239, v238, v238
    v_fmac_f32 v240, 0xbdd2d3e8, v239
    v_mul_f32 v240, v240, v238
    v_exp_f32 v240, v240
    s_mov_b32 exec_lo, -1
    v_add_f32 v240, 1.0, v240
    v_rcp_f32 v240, v240
    s_nop 0
    v_mul_f32 v238, v238, v240
    s_nop 1
    v_mov_b32_dpp v239, v238 quad_perm:[1,0,3,2] row_mask:0xf bank_mask:0xf
    v_cvt_pk_bf16_f32 v238, v238, v239
    s_mov_b32 exec_lo, 0x55555555
    s_mov_b32 exec_hi, 0x55555555
    buffer_store_dword v238, v14, s[52:55], s93 offen
    buffer_store_dword v238, v14, s[56:59], s93 offen sc1
    s_mov_b64 exec, -1
    s_cmp_lg_u32 s85, 0
    s_cbranch_scc1 LFIN
    s_branch LQ2P
LR:
    s_nop 15
    s_nop 15
    s_nop 15
    s_nop 15
    s_nop 15
    s_nop 15
    s_nop 15
    s_nop 15
    s_nop 15
    s_nop 15
    s_mov_b32 s98, s91
    v_lshlrev_b32 v246, 4, v1
    s_mov_b64 s[32:33], -1
    s_mov_b64 s[34:35], -1
    s_mov_b64 s[64:65], -1
    s_mov_b64 s[66:67], -1
Lrl29:
    s_mov_b64 exec, s[32:33]
    buffer_load_dwordx4 v[106:109], v246, s[48:51], s98 offen sc1
    s_mov_b64 exec, s[34:35]
    buffer_load_dwordx4 v[110:113], v246, s[48:51], s98 offen offset:1024 sc1
    s_mov_b64 exec, s[64:65]
    buffer_load_dwordx4 v[114:117], v246, s[48:51], s98 offen offset:2048 sc1
    s_mov_b64 exec, s[66:67]
    buffer_load_dwordx4 v[118:121], v246, s[48:51], s98 offen offset:3072 sc1
    s_mov_b64 exec, -1
    s_waitcnt vmcnt(20)
Lck31:
    v_pk_add_f32 v[238:239], v[106:107], v[108:109]
    v_pk_add_f32 v[240:241], v[110:111], v[112:113]
    v_pk_add_f32 v[242:243], v[114:115], v[116:117]
    v_pk_add_f32 v[244:245], v[118:119], v[120:121]
    v_cmp_u_f32 s[32:33], v238, v239
    v_cmp_u_f32 s[34:35], v240, v241
    v_cmp_u_f32 s[64:65], v242, v243
    v_cmp_u_f32 s[66:67], v244, v245
    v_pk_add_f32 v[238:239], v[106:107], v[110:111]
    v_pk_add_f32 v[240:241], v[108:109], v[112:113]
    v_pk_add_f32 v[242:243], v[114:115], v[118:119]
    v_pk_add_f32 v[244:245], v[116:117], v[120:121]
    s_or_b64 s[96:97], s[64:65], s[66:67]
    v_pk_add_f32 v[238:239], v[238:239], v[242:243]
    v_pk_add_f32 v[240:241], v[240:241], v[244:245]
    s_or_b64 s[96:97], s[96:97], s[34:35]
    s_or_b64 s[96:97], s[96:97], s[32:33]
    s_cbranch_scc0 Lok30
    s_sub_u32 s83, s83, 1
    s_cselect_b32 s83, 0, s83
    s_cbranch_scc1 Lok30
    v_max3_u32 v251, v106, v110, v114
    v_max_u32 v251, v251, v118
    v_cmp_eq_u32 vcc, -1, v251
    s_cbranch_vccz Lck31
    s_nop 3
    v_max3_u32 v251, v106, v110, v114
    v_max_u32 v251, v251, v118
    v_cmp_eq_u32 vcc, -1, v251
    s_cbranch_vccz Lck31
    s_nop 3
    v_max3_u32 v251, v106, v110, v114
    v_max_u32 v251, v251, v118
    v_cmp_eq_u32 vcc, -1, v251
    s_cbranch_vccz Lck31
    s_nop 3
    v_max3_u32 v251, v106, v110, v114
    v_max_u32 v251, v251, v118
    v_cmp_eq_u32 vcc, -1, v251
    s_cbranch_vccz Lck31
    s_nop 3
    v_max3_u32 v251, v106, v110, v114
    v_max_u32 v251, v251, v118
    v_cmp_eq_u32 vcc, -1, v251
    s_cbranch_vccz Lck31
    s_nop 3
    v_max3_u32 v251, v106, v110, v114
    v_max_u32 v251, v251, v118
    v_cmp_eq_u32 vcc, -1, v251
    s_cbranch_vccz Lck31
    s_nop 3
    v_max3_u32 v251, v106, v110, v114
    v_max_u32 v251, v251, v118
    v_cmp_eq_u32 vcc, -1, v251
    s_cbranch_vccz Lck31
    s_nop 3
    s_sub_u32 s83, s83, 1
    s_cbranch_scc0 Lrl29
    s_mov_b32 s83, 0
Lok30:
    v_permlane32_swap_b32 v238, v240
    v_permlane32_swap_b32 v239, v241
    v_pk_add_f32 v[238:239], v[238:239], v[240:241]
    s_nop 1
    v_permlane16_swap_b32 v238, v239
    v_add_f32 v238, v238, v239
    v_cvt_pk_bf16_f32 v238, v238, v238
    v_lshlrev_b32 v238, 16, v238
    v_add_f32 v238, v238, v29
    v_mov_b32 v240, v238
    v_cvt_pk_bf16_f32 v241, v238, v238
    s_nop 0
    v_permlane16_swap_b32 v238, v240
    s_mov_b32 exec_lo, 0xffff
    s_mov_b32 exec_hi, 0xffff
    v_cvt_pk_bf16_f32 v239, v238, v240
    buffer_store_dword v239, v14, s[52:55], s92 offen
    buffer_store_dword v239, v14, s[56:59], s92 offen sc1
    s_mov_b64 exec, -1
    v_lshlrev_b32 v29, 16, v241
    s_cmp_eq_u32 s85, 0
    s_cbranch_scc1 Lrg32
    s_cmp_eq_u32 s31, 0
    s_cbranch_scc1 LFIN
Lrg32:
    s_cmp_lg_u32 s85, 0
    s_cbranch_scc1 Lnp33
    s_sub_u32 s98, s91, 1048576
    s_lshr_b32 s98, s98, 11
    s_mul_i32 s98, s98, 43691
    s_lshr_b32 s98, s98, 19
    s_and_b32 s99, s82, 7
    s_lshl_b32 s99, s99, 7
    s_lshl_b32 s100, s80, 8
    s_add_u32 s44, s40, s100
    s_addc_u32 s45, s41, 0
    s_sub_u32 s44, s44, s99
    s_subb_u32 s45, s45, 0
    s_add_u32 s46, s42, s99
    s_sub_u32 s46, s46, s100
    s_mov_b32 s47, 0x20000
    s_lshl_b32 s76, s98, 19
    s_mov_b32 s75, 65536
    v_lshrrev_b32 v241, 3, v1
    v_mul_u32_u24 v241, 7040, v241
    v_add_u32 v25, v25, v241
    v_xor_b32 v26, 64, v25
    s_barrier
    s_add_u32 m0, s79, 0
    s_nop 0
    buffer_load_dwordx4 v25, s[44:47], s76 offen lds
    s_add_u32 s76, s76, s75
    s_add_u32 m0, s79, 1024
    s_nop 0
    buffer_load_dwordx4 v26, s[44:47], s76 offen lds
    s_add_u32 s76, s76, s75
    s_add_u32 m0, s79, 2048
    s_nop 0
    buffer_load_dwordx4 v25, s[44:47], s76 offen lds
    s_add_u32 s76, s76, s75
    s_add_u32 m0, s79, 3072
    s_nop 0
    buffer_load_dwordx4 v26, s[44:47], s76 offen lds
    s_add_u32 s76, s76, s75
    s_add_u32 m0, s79, 4096
    s_nop 0
    buffer_load_dwordx4 v25, s[44:47], s76 offen lds
    s_add_u32 s76, s76, s75
    s_add_u32 m0, s79, 5120
    s_nop 0
    buffer_load_dwordx4 v26, s[44:47], s76 offen lds
    s_add_u32 s76, s76, s75
    s_add_u32 m0, s79, 6144
    s_nop 0
    buffer_load_dwordx4 v25, s[44:47], s76 offen lds
    s_add_u32 s76, s76, s75
    s_add_u32 m0, s79, 7168
    s_nop 0
    buffer_load_dwordx4 v26, s[44:47], s76 offen lds
    s_add_u32 s76, s76, s75
    s_lshl_b32 s76, s98, 19
    s_add_u32 s76, s76, 128
    s_add_u32 m0, s79, 8192
    s_nop 0
    buffer_load_dwordx4 v25, s[44:47], s76 offen lds
    s_add_u32 s76, s76, s75
    s_add_u32 m0, s79, 9216
    s_nop 0
    buffer_load_dwordx4 v26, s[44:47], s76 offen lds
    s_add_u32 s76, s76, s75
    s_add_u32 m0, s79, 10240
    s_nop 0
    buffer_load_dwordx4 v25, s[44:47], s76 offen lds
    s_add_u32 s76, s76, s75
    s_add_u32 m0, s79, 11264
    s_nop 0
    buffer_load_dwordx4 v26, s[44:47], s76 offen lds
    s_add_u32 s76, s76, s75
    s_add_u32 m0, s79, 12288
    s_nop 0
    buffer_load_dwordx4 v25, s[44:47], s76 offen lds
    s_add_u32 s76, s76, s75
    s_add_u32 m0, s79, 13312
    s_nop 0
    buffer_load_dwordx4 v26, s[44:47], s76 offen lds
    s_add_u32 s76, s76, s75
    s_add_u32 m0, s79, 14336
    s_nop 0
    buffer_load_dwordx4 v25, s[44:47], s76 offen lds
    s_add_u32 s76, s76, s75
    s_add_u32 m0, s79, 15360
    s_nop 0
    buffer_load_dwordx4 v26, s[44:47], s76 offen lds
    s_add_u32 s76, s76, s75
    s_add_u32 s72, s87, 56832
    s_add_u32 s73, s87, 130560
    s_mul_i32 s99, s98, 43691
    s_lshr_b32 s99, s99, 17
    s_mul_i32 s100, s99, 3
    s_sub_u32 s100, s98, s100
    s_mul_i32 s99, s99, 24576
    s_lshl_b32 s100, s100, 8
    s_add_u32 s99, s99, s100
    s_mul_i32 s100, s80, 1536
    s_add_u32 s99, s99, s100
    v_and_b32 v239, 15, v1
    v_lshrrev_b32 v240, 4, v1
    v_and_b32 v242, 3, v1
    v_mul_u32_u24 v6, 6144, v242
    v_lshl_add_u32 v6, v240, 4, v6
    v_bfe_u32 v241, v1, 2, 2
    v_lshl_add_u32 v6, v241, 6, v6
    v_add_u32 v6, s99, v6
    s_lshl_b32 s99, s98, 3
    s_add_u32 s99, s99, 4
    v_lshl_add_u32 v7, v239, 7, s99
    v_lshlrev_b32 v241, 2, v240
    v_sub_u32 v7, v7, v241
    v_and_b32 v241, 44, v1
    v_cmp_ne_u32 vcc, 0, v241
    v_mov_b32 v241, 0x40000000
    s_nop 0
    v_cndmask_b32 v7, v7, v241, vcc
    s_lshl_b32 s99, s98, 9
    s_sub_u32 s99, 157696, s99
    v_add_u32 v4, s99, v14
    v_lshlrev_b32 v34, 6, v242
    v_lshl_add_u32 v34, v240, 4, v34
    v_add_u32 v34, 157696, v34
    v_lshrrev_b32 v238, 4, v1
    v_bfe_u32 v239, v1, 2, 2
    v_lshl_add_u32 v239, v238, 3, v239
    v_lshl_add_u32 v239, v239, 7, s79
    v_and_b32 v240, 3, v1
    v_lshl_add_u32 v239, v240, 3, v239
    v_bfe_u32 v240, v1, 3, 2
    v_lshl_add_u32 v242, v240, 5, v239
    v_xor_b32 v243, 32, v242
    v_xor_b32 v244, 64, v242
    v_xor_b32 v245, 96, v242
    s_waitcnt vmcnt(0)
    ds_read_b64_tr_b16 v[74:75], v242 offset:0
    ds_read_b64_tr_b16 v[76:77], v242 offset:512
    ds_read_b64_tr_b16 v[82:83], v243 offset:0
    ds_read_b64_tr_b16 v[84:85], v243 offset:512
    ds_read_b64_tr_b16 v[90:91], v244 offset:0
    ds_read_b64_tr_b16 v[92:93], v244 offset:512
    ds_read_b64_tr_b16 v[98:99], v245 offset:0
    ds_read_b64_tr_b16 v[100:101], v245 offset:512
    ds_read_b64_tr_b16 v[78:79], v242 offset:4096
    ds_read_b64_tr_b16 v[80:81], v242 offset:4608
    ds_read_b64_tr_b16 v[86:87], v243 offset:4096
    ds_read_b64_tr_b16 v[88:89], v243 offset:4608
    s_waitcnt lgkmcnt(4)
    ds_read_b64_tr_b16 v[94:95], v244 offset:4096
    ds_read_b64_tr_b16 v[96:97], v244 offset:4608
    ds_read_b64_tr_b16 v[102:103], v245 offset:4096
    ds_read_b64_tr_b16 v[104:105], v245 offset:4608
    s_waitcnt lgkmcnt(0)
    v_lshrrev_b32 v238, 4, v1
    v_bfe_u32 v239, v1, 2, 2
    v_lshl_add_u32 v239, v238, 3, v239
    v_lshl_add_u32 v239, v239, 7, s79
    v_and_b32 v240, 3, v1
    v_lshl_add_u32 v239, v240, 3, v239
    v_bfe_u32 v240, v1, 3, 2
    v_lshl_add_u32 v242, v240, 5, v239
    v_xor_b32 v243, 32, v242
    v_xor_b32 v244, 64, v242
    v_xor_b32 v245, 96, v242
    ds_read_b64_tr_b16 v[130:131], v242 offset:8192
    ds_read_b64_tr_b16 v[132:133], v242 offset:8704
    ds_read_b64_tr_b16 v[138:139], v243 offset:8192
    ds_read_b64_tr_b16 v[140:141], v243 offset:8704
    ds_read_b64_tr_b16 v[146:147], v244 offset:8192
    ds_read_b64_tr_b16 v[148:149], v244 offset:8704
    ds_read_b64_tr_b16 v[58:59], v245 offset:8192
    ds_read_b64_tr_b16 v[60:61], v245 offset:8704
    ds_read_b64_tr_b16 v[134:135], v242 offset:12288
    ds_read_b64_tr_b16 v[136:137], v242 offset:12800
    ds_read_b64_tr_b16 v[142:143], v243 offset:12288
    ds_read_b64_tr_b16 v[144:145], v243 offset:12800
    s_waitcnt lgkmcnt(4)
    ds_read_b64_tr_b16 v[150:151], v244 offset:12288
    ds_read_b64_tr_b16 v[152:153], v244 offset:12800
    ds_read_b64_tr_b16 v[62:63], v245 offset:12288
    ds_read_b64_tr_b16 v[64:65], v245 offset:12800
    s_waitcnt lgkmcnt(0)
    v_mov_b32 v190, -1
    v_mov_b32 v191, -1
    v_mov_b32 v192, -1
    v_mov_b32 v193, -1
    v_mov_b32 v194, -1
    v_mov_b32 v195, -1
    v_mov_b32 v196, -1
    v_mov_b32 v197, -1
    v_mov_b32 v198, -1
    v_mov_b32 v199, -1
    v_mov_b32 v200, -1
    v_mov_b32 v201, -1
    v_mov_b32 v54, -1
    v_mov_b32 v55, -1
    s_add_u32 s72, s87, 56832
    s_add_u32 s73, s87, 130560
    v_and_b32 v239, 15, v1
    v_lshrrev_b32 v240, 4, v1
    s_bfe_u32 s98, s82, 0x20001
    s_mul_i32 s99, s98, 6144
    s_and_b32 s100, s82, 1
    s_lshl_b32 s100, s100, 2
    s_add_u32 s100, s100, s80
    s_mul_i32 s100, s100, 768
    s_add_u32 s99, s99, s100
    v_mul_u32_u24 v5, 24576, v240
    v_lshl_add_u32 v5, v239, 4, v5
    v_add_u32 v5, s99, v5
    v_mov_b32 v241, 0x40000000
    v_cmp_eq_u32 vcc, 3, v240
    s_nop 1
    v_cndmask_b32 v5, v5, v241, vcc
    s_lshl_b32 s98, s98, 7
    v_lshl_add_u32 v38, v239, 3, s98
    v_cmp_lt_u32 vcc, 8, v239
    s_nop 1
    v_cndmask_b32 v38, v38, v241, vcc
    v_lshl_add_u32 v241, v239, 2, v240
    v_lshlrev_b32 v242, 2, v241
    ds_bpermute_b32 v30, v242, v30
    s_lshl_b32 s98, s80, 7
    s_add_u32 s98, s98, 157184
    v_lshl_add_u32 v8, v241, 1, s98
    s_waitcnt lgkmcnt(0)
    v_mov_b32 v210, 0
    v_mov_b32 v211, 0
    v_mov_b32 v212, 0
    v_mov_b32 v213, 0
    v_mov_b32 v214, 0
    v_mov_b32 v215, 0
    v_mov_b32 v216, 0
    v_mov_b32 v217, 0
    v_mov_b32 v218, 0
    v_mov_b32 v219, 0
    v_mov_b32 v220, 0
    v_mov_b32 v221, 0
    v_mov_b32 v222, 0
    v_mov_b32 v223, 0
    v_mov_b32 v224, 0
    v_mov_b32 v225, 0
    v_mov_b32 v226, 0
    v_mov_b32 v227, 0
    v_mov_b32 v228, 0
    v_mov_b32 v229, 0
    v_mov_b32 v230, 0
    v_mov_b32 v231, 0
    v_mov_b32 v232, 0
    v_mov_b32 v233, 0
    v_mov_b32 v174, 0
    v_mov_b32 v175, 0
    v_mov_b32 v176, 0
    v_mov_b32 v177, 0
    v_mov_b32 v178, 0
    v_mov_b32 v179, 0
    v_mov_b32 v180, 0
    v_mov_b32 v181, 0
    s_branch LRE1
Lnp33:
LRG:
Lg34:
    buffer_load_dword v238, off, s[48:51], s93 sc1
    s_waitcnt vmcnt(0)
    v_cmp_eq_u32 vcc, -1, v238
    s_cbranch_vccz Lok35
    s_sub_u32 s83, s83, 1
    s_cbranch_scc0 Lg34
    s_mov_b32 s83, 0
Lok35:
LRE1:
    s_nop 15
    s_nop 15
    s_nop 15
    s_nop 15
    s_nop 15
    s_nop 15
    s_nop 15
    s_nop 15
    s_nop 15
    s_nop 15
LRE2:
    s_add_u32 s98, s91, 4096
    v_lshlrev_b32 v246, 4, v1
    s_mov_b64 s[32:33], -1
    s_mov_b64 s[34:35], -1
Lrl36:
    s_mov_b64 exec, s[32:33]
    buffer_load_dwordx4 v[122:125], v246, s[48:51], s98 offen sc1
    s_mov_b64 exec, s[34:35]
    buffer_load_dwordx4 v[126:129], v246, s[48:51], s98 offen offset:1024 sc1
    s_mov_b64 exec, -1
    s_waitcnt vmcnt(10)
Lck38:
    v_pk_add_f32 v[238:239], v[122:123], v[124:125]
    v_pk_add_f32 v[240:241], v[126:127], v[128:129]
    v_cmp_u_f32 s[32:33], v238, v239
    v_cmp_u_f32 s[34:35], v240, v241
    v_pk_add_f32 v[238:239], v[122:123], v[126:127]
    v_pk_add_f32 v[240:241], v[124:125], v[128:129]
    s_or_b64 s[96:97], s[32:33], s[34:35]
    s_cbranch_scc0 Lok37
    s_sub_u32 s83, s83, 1
    s_cselect_b32 s83, 0, s83
    s_cbranch_scc1 Lok37
    v_max_u32 v251, v122, v126
    v_cmp_eq_u32 vcc, -1, v251
    s_cbranch_vccz Lck38
    s_nop 4
    v_max_u32 v251, v122, v126
    v_cmp_eq_u32 vcc, -1, v251
    s_cbranch_vccz Lck38
    s_nop 4
    v_max_u32 v251, v122, v126
    v_cmp_eq_u32 vcc, -1, v251
    s_cbranch_vccz Lck38
    s_nop 4
    v_max_u32 v251, v122, v126
    v_cmp_eq_u32 vcc, -1, v251
    s_cbranch_vccz Lck38
    s_nop 4
    v_max_u32 v251, v122, v126
    v_cmp_eq_u32 vcc, -1, v251
    s_cbranch_vccz Lck38
    s_nop 4
    v_max_u32 v251, v122, v126
    v_cmp_eq_u32 vcc, -1, v251
    s_cbranch_vccz Lck38
    s_nop 4
    s_sub_u32 s83, s83, 1
    s_cbranch_scc0 Lrl36
    s_mov_b32 s83, 0
Lok37:
    v_permlane32_swap_b32 v238, v240
    v_permlane32_swap_b32 v239, v241
    v_pk_add_f32 v[238:239], v[238:239], v[240:241]
    s_nop 1
    v_permlane16_swap_b32 v238, v239
    v_add_f32 v238, v238, v239
    v_cvt_pk_bf16_f32 v238, v238, v238
    v_lshlrev_b32 v238, 16, v238
    v_add_f32 v238, v238, v28
    v_cvt_pk_bf16_f32 v238, v238, v238
    v_lshlrev_b32 v238, 16, v238
    v_add_f32 v238, v238, v29
    v_mov_b32 v240, v238
    v_cvt_pk_bf16_f32 v241, v238, v238
    s_nop 0
    v_permlane16_swap_b32 v238, v240
    s_mov_b32 exec_lo, 0xffff
    s_mov_b32 exec_hi, 0xffff
    v_cvt_pk_bf16_f32 v239, v238, v240
    s_cmp_lg_u32 s85, 0
    s_cbranch_scc1 Lrf39
    ds_write_b32 v4, v239
    s_mov_b64 exec, -1
    v_lshlrev_b32 v29, 16, v241
LRQ:
    s_waitcnt lgkmcnt(0)
    s_barrier
    s_mov_b64 exec, s[94:95]
    ds_read_b128 v[174:177], v34
    ds_read_b128 v[178:181], v34 offset:256
    ds_read_b128 v[154:157], v34
    ds_read_b128 v[158:161], v34 offset:256
    s_lshl_b64 exec, s[94:95], 4
    ds_read_b128 v[210:213], v34
    ds_read_b128 v[214:217], v34 offset:256
    s_lshl_b64 exec, s[94:95], 8
    ds_read_b128 v[218:221], v34
    ds_read_b128 v[222:225], v34 offset:256
    s_lshl_b64 exec, s[94:95], 12
    ds_read_b128 v[226:229], v34
    ds_read_b128 v[230:233], v34 offset:256
    s_mov_b64 exec, -1
    s_waitcnt lgkmcnt(9)
    v_mfma_f32_16x16x32_bf16 v[202:205], v[74:77], v[174:177], 0
    v_mfma_f32_16x16x32_bf16 v[206:209], v[130:133], v[174:177], 0
    s_waitcnt lgkmcnt(8)
    v_mfma_f32_16x16x32_bf16 v[202:205], v[78:81], v[178:181], v[202:205]
    v_mfma_f32_16x16x32_bf16 v[206:209], v[134:137], v[178:181], v[206:209]
    s_waitcnt lgkmcnt(5)
    v_mfma_f32_16x16x32_bf16 v[234:237], v[154:157], v[154:157], 0
    v_mfma_f32_16x16x32_bf16 v[202:205], v[82:85], v[210:213], v[202:205]
    v_mfma_f32_16x16x32_bf16 v[206:209], v[138:141], v[210:213], v[206:209]
    s_waitcnt lgkmcnt(4)
    v_mfma_f32_16x16x32_bf16 v[234:237], v[158:161], v[158:161], v[234:237]
    v_mfma_f32_16x16x32_bf16 v[202:205], v[86:89], v[214:217], v[202:205]
    v_mfma_f32_16x16x32_bf16 v[206:209], v[142:145], v[214:217], v[206:209]
    s_waitcnt lgkmcnt(3)
    v_mfma_f32_16x16x32_bf16 v[202:205], v[90:93], v[218:221], v[202:205]
    v_mfma_f32_16x16x32_bf16 v[206:209], v[146:149], v[218:221], v[206:209]
    s_waitcnt lgkmcnt(2)
    v_mfma_f32_16x16x32_bf16 v[202:205], v[94:97], v[222:225], v[202:205]
    s_mov_b64 s[96:97], 2
    v_cndmask_b32 v234, v234, v235, s[96:97]
    v_mfma_f32_16x16x32_bf16 v[206:209], v[150:153], v[222:225], v[206:209]
    s_mov_b64 s[96:97], 4
    s_waitcnt lgkmcnt(1)
    v_mfma_f32_16x16x32_bf16 v[202:205], v[98:101], v[226:229], v[202:205]
    v_cndmask_b32 v234, v234, v236, s[96:97]
    s_mov_b64 s[96:97], 8
    v_mfma_f32_16x16x32_bf16 v[206:209], v[58:61], v[226:229], v[206:209]
    v_cndmask_b32 v234, v234, v237, s[96:97]
    s_waitcnt lgkmcnt(0)
    v_mfma_f32_16x16x32_bf16 v[202:205], v[102:105], v[230:233], v[202:205]
    buffer_store_dword v234, v7, s[52:55], s73 offen
    v_mfma_f32_16x16x32_bf16 v[206:209], v[62:65], v[230:233], v[206:209]
    buffer_store_dword v234, v7, s[56:59], s73 offen sc1
    s_nop 4
    buffer_store_dwordx4 v[202:205], v6, s[52:55], s72 offen
    s_nop 0
    buffer_store_dwordx4 v[206:209], v6, s[52:55], s72 offen offset:768
    buffer_store_dwordx4 v[202:205], v6, s[56:59], s72 offen sc1
    buffer_store_dwordx4 v[206:209], v6, s[56:59], s72 offen offset:768 sc1
    s_branch LQ2
Lrf39:
    buffer_store_dword v239, v15, s[60:63], 0 offen
    s_mov_b64 exec, -1
    s_branch LFIN
LQ2P:
    s_waitcnt vmcnt(0)
    v_mov_b32 v190, -1
    v_mov_b32 v191, -1
    v_mov_b32 v192, -1
    v_mov_b32 v193, -1
    v_mov_b32 v194, -1
    v_mov_b32 v195, -1
    v_mov_b32 v196, -1
    v_mov_b32 v197, -1
    v_mov_b32 v198, -1
    v_mov_b32 v199, -1
    v_mov_b32 v200, -1
    v_mov_b32 v201, -1
    v_mov_b32 v54, -1
    v_mov_b32 v55, -1
    s_add_u32 s72, s87, 56832
    s_add_u32 s73, s87, 130560
    v_and_b32 v239, 15, v1
    v_lshrrev_b32 v240, 4, v1
    s_bfe_u32 s98, s82, 0x20001
    s_mul_i32 s99, s98, 6144
    s_and_b32 s100, s82, 1
    s_lshl_b32 s100, s100, 2
    s_add_u32 s100, s100, s80
    s_mul_i32 s100, s100, 768
    s_add_u32 s99, s99, s100
    v_mul_u32_u24 v5, 24576, v240
    v_lshl_add_u32 v5, v239, 4, v5
    v_add_u32 v5, s99, v5
    v_mov_b32 v241, 0x40000000
    v_cmp_eq_u32 vcc, 3, v240
    s_nop 1
    v_cndmask_b32 v5, v5, v241, vcc
    s_lshl_b32 s98, s98, 7
    v_lshl_add_u32 v38, v239, 3, s98
    v_cmp_lt_u32 vcc, 8, v239
    s_nop 1
    v_cndmask_b32 v38, v38, v241, vcc
    v_lshl_add_u32 v241, v239, 2, v240
    v_lshlrev_b32 v242, 2, v241
    ds_bpermute_b32 v30, v242, v30
    s_lshl_b32 s98, s80, 7
    s_add_u32 s98, s98, 157184
    v_lshl_add_u32 v8, v241, 1, s98
    s_waitcnt lgkmcnt(0)
LQ2:
La240:
    buffer_load_dwordx4 v[190:193], v5, s[48:51], s72 offen sc1
    buffer_load_dwordx4 v[194:197], v5, s[48:51], s72 offen offset:256 sc1
    buffer_load_dwordx4 v[198:201], v5, s[48:51], s72 offen offset:512 sc1
    buffer_load_dwordx2 v[54:55], v38, s[48:51], s73 offen sc1
    s_waitcnt vmcnt(12)
    v_max3_u32 v251, v190, v194, v198
    v_max3_u32 v251, v251, v54, v55
    v_cmp_eq_u32 vcc, -1, v251
    s_cbranch_vccz Lgo41
    s_nop 3
    v_max3_u32 v251, v190, v194, v198
    v_max3_u32 v251, v251, v54, v55
    v_cmp_eq_u32 vcc, -1, v251
    s_cbranch_vccz Lgo41
    s_nop 3
    v_max3_u32 v251, v190, v194, v198
    v_max3_u32 v251, v251, v54, v55
    v_cmp_eq_u32 vcc, -1, v251
    s_cbranch_vccz Lgo41
    s_nop 3
    v_max3_u32 v251, v190, v194, v198
    v_max3_u32 v251, v251, v54, v55
    v_cmp_eq_u32 vcc, -1, v251
    s_cbranch_vccz Lgo41
    s_nop 3
    v_max3_u32 v251, v190, v194, v198
    v_max3_u32 v251, v251, v54, v55
    v_cmp_eq_u32 vcc, -1, v251
    s_cbranch_vccz Lgo41
    s_nop 3
    v_max3_u32 v251, v190, v194, v198
    v_max3_u32 v251, v251, v54, v55
    v_cmp_eq_u32 vcc, -1, v251
    s_cbranch_vccz Lgo41
    s_nop 3
    s_sub_u32 s83, s83, 1
    s_cbranch_scc0 La240
    s_mov_b32 s83, 0
Lgo41:
    v_add_f32_dpp v244, v54, v54 row_ror:8 row_mask:0xf bank_mask:0xf
    v_add_f32_dpp v245, v55, v55 row_ror:8 row_mask:0xf bank_mask:0xf
    v_pk_add_f32 v[238:239], v[190:191], v[194:195]
    v_pk_add_f32 v[240:241], v[192:193], v[196:197]
    v_add_f32_dpp v244, v244, v244 row_ror:4 row_mask:0xf bank_mask:0xf
    v_add_f32_dpp v245, v245, v245 row_ror:4 row_mask:0xf bank_mask:0xf
    v_pk_add_f32 v[238:239], v[238:239], v[198:199]
    v_pk_add_f32 v[240:241], v[240:241], v[200:201]
    v_add_f32_dpp v244, v244, v244 row_ror:2 row_mask:0xf bank_mask:0xf
    v_add_f32_dpp v245, v245, v245 row_ror:2 row_mask:0xf bank_mask:0xf
    v_permlane32_swap_b32 v238, v240
    v_permlane32_swap_b32 v239, v241
    v_add_f32_dpp v244, v244, v244 row_ror:1 row_mask:0xf bank_mask:0xf
    v_add_f32_dpp v245, v245, v245 row_ror:1 row_mask:0xf bank_mask:0xf
    v_pk_add_f32 v[238:239], v[238:239], v[240:241]
    v_mov_b32 v243, s30
    v_mul_f32 v244, s29, v244
    v_fma_f32 v245, v245, s29, v243
    v_permlane16_swap_b32 v238, v239
    v_fma_f32 v245, -v244, v244, v245
    v_add_f32 v242, v238, v239
    v_rsq_f32 v245, v245
    v_fma_f32 v242, -v244, v30, v242
    v_mul_f32 v242, v242, v245
    v_cmp_u_f32 vcc, v242, v242
    v_cvt_pk_bf16_f32 v242, v242, v242
    s_cbranch_vccz Lok42
    s_sub_u32 s83, s83, 1
    s_cbranch_scc0 La240
    s_mov_b32 s83, 0
Lok42:
    ds_write_b16 v8, v242
    s_waitcnt lgkmcnt(0)
    s_barrier
    ds_read_b128 v[174:177], v9 offset:0
    ds_read_b128 v[178:181], v9 offset:64
    ds_read_b128 v[182:185], v9 offset:128
    ds_read_b128 v[186:189], v9 offset:192
    s_waitcnt lgkmcnt(3)
    v_mfma_f32_16x16x32_bf16 v[234:237], a[0:3], v[174:177], 0
    s_waitcnt lgkmcnt(2)
    v_mfma_f32_16x16x32_bf16 v[234:237], a[4:7], v[178:181], v[234:237]
    s_waitcnt lgkmcnt(1)
    v_mfma_f32_16x16x32_bf16 v[234:237], a[8:11], v[182:185], v[234:237]
    s_waitcnt lgkmcnt(0)
    v_mfma_f32_16x16x32_bf16 v[234:237], a[12:15], v[186:189], v[234:237]
    v_mfma_f32_16x16x32_bf16 v[206:209], a[16:19], v[174:177], 0
    s_mov_b32 s85, 1
    s_add_u32 s90, s90, 221184
    v_mfma_f32_16x16x32_bf16 v[206:209], a[20:23], v[178:181], v[206:209]
    s_add_u32 s91, s91, 221184
    s_add_u32 s88, s87, 16384
    v_mfma_f32_16x16x32_bf16 v[206:209], a[24:27], v[182:185], v[206:209]
    s_add_u32 s89, s87, 33280
    s_add_u32 s92, s87, 43008
    v_mfma_f32_16x16x32_bf16 v[206:209], a[28:31], v[186:189], v[206:209]
    s_add_u32 s93, s87, 52224
    s_and_b32 s98, s82, 1
    v_mfma_f32_16x16x32_bf16 v[202:205], a[32:35], v[174:177], 0
    s_mov_b32 s96, 0xc000c
    s_mov_b32 s97, 0xc000c
    v_mfma_f32_16x16x32_bf16 v[202:205], a[36:39], v[178:181], v[202:205]
    s_lshl_b32 s98, s98, 1
    s_add_u32 s99, s98, s80
    v_mfma_f32_16x16x32_bf16 v[202:205], a[40:43], v[182:185], v[202:205]
    s_lshl_b32 s99, s99, 12
    s_bfe_u32 s100, s82, 0x20001
    v_mfma_f32_16x16x32_bf16 v[202:205], a[44:47], v[186:189], v[202:205]
    v_cndmask_b32 v234, v234, v206, s[96:97]
    v_cndmask_b32 v235, v235, v207, s[96:97]
    v_cndmask_b32 v236, v236, v208, s[96:97]
    v_cndmask_b32 v237, v237, v209, s[96:97]
    v_mfma_f32_16x16x32_bf16 v[206:209], a[48:51], v[174:177], 0
    s_mov_b32 s96, 0x300030
    s_mov_b32 s97, 0x300030
    v_mfma_f32_16x16x32_bf16 v[206:209], a[52:55], v[178:181], v[206:209]
    s_lshr_b32 s101, s82, 3
    s_lshl_b32 s27, s100, 2
    v_mfma_f32_16x16x32_bf16 v[206:209], a[56:59], v[182:185], v[206:209]
    s_add_u32 s27, s27, s101
    s_lshl_b32 s27, s27, 6
    v_mfma_f32_16x16x32_bf16 v[206:209], a[60:63], v[186:189], v[206:209]
    v_cndmask_b32 v234, v234, v202, s[96:97]
    v_cndmask_b32 v235, v235, v203, s[96:97]
    v_cndmask_b32 v236, v236, v204, s[96:97]
    v_cndmask_b32 v237, v237, v205, s[96:97]
    v_mfma_f32_16x16x32_bf16 v[202:205], a[64:67], v[174:177], 0
    s_mov_b32 s96, 0xc000c0
    s_mov_b32 s97, 0xc000c0
    v_mfma_f32_16x16x32_bf16 v[202:205], a[68:71], v[178:181], v[202:205]
    s_add_u32 s27, s27, s99
    s_add_u32 s27, s27, s88
    v_mfma_f32_16x16x32_bf16 v[202:205], a[72:75], v[182:185], v[202:205]
    s_lshl_b32 s99, s98, 2
    s_add_u32 s99, s99, s100
    v_mfma_f32_16x16x32_bf16 v[202:205], a[76:79], v[186:189], v[202:205]
    v_cndmask_b32 v234, v234, v206, s[96:97]
    v_cndmask_b32 v235, v235, v207, s[96:97]
    v_cndmask_b32 v236, v236, v208, s[96:97]
    v_cndmask_b32 v237, v237, v209, s[96:97]
    v_mfma_f32_16x16x32_bf16 v[206:209], a[80:83], v[174:177], 0
    s_mov_b32 s96, 0x3000300
    s_mov_b32 s97, 0x3000300
    v_mfma_f32_16x16x32_bf16 v[206:209], a[84:87], v[178:181], v[206:209]
    s_lshl_b32 s99, s99, 5
    s_lshl_b32 s101, s101, 2
    v_mfma_f32_16x16x32_bf16 v[206:209], a[88:91], v[182:185], v[206:209]
    s_add_u32 s99, s99, s101
    s_add_u32 s28, s99, s89
    v_mfma_f32_16x16x32_bf16 v[206:209], a[92:95], v[186:189], v[206:209]
    v_cndmask_b32 v234, v234, v202, s[96:97]
    v_cndmask_b32 v235, v235, v203, s[96:97]
    v_cndmask_b32 v236, v236, v204, s[96:97]
    v_cndmask_b32 v237, v237, v205, s[96:97]
    v_mfma_f32_16x16x32_bf16 v[202:205], a[96:99], v[174:177], 0
    s_mov_b32 s96, 0xc000c00
    s_mov_b32 s97, 0xc000c00
    v_mfma_f32_16x16x32_bf16 v[202:205], a[100:103], v[178:181], v[202:205]
    v_mfma_f32_16x16x32_bf16 v[202:205], a[104:107], v[182:185], v[202:205]
    v_mfma_f32_16x16x32_bf16 v[202:205], a[108:111], v[186:189], v[202:205]
    v_cndmask_b32 v234, v234, v206, s[96:97]
    v_cndmask_b32 v235, v235, v207, s[96:97]
    v_cndmask_b32 v236, v236, v208, s[96:97]
    v_cndmask_b32 v237, v237, v209, s[96:97]
    v_mfma_f32_16x16x32_bf16 v[206:209], a[112:115], v[174:177], 0
    s_mov_b32 s96, 0x30003000
    s_mov_b32 s97, 0x30003000
    v_mfma_f32_16x16x32_bf16 v[206:209], a[116:119], v[178:181], v[206:209]
    v_mfma_f32_16x16x32_bf16 v[206:209], a[120:123], v[182:185], v[206:209]
    v_mfma_f32_16x16x32_bf16 v[206:209], a[124:127], v[186:189], v[206:209]
    v_cndmask_b32 v234, v234, v202, s[96:97]
    v_cndmask_b32 v235, v235, v203, s[96:97]
    v_cndmask_b32 v236, v236, v204, s[96:97]
    v_cndmask_b32 v237, v237, v205, s[96:97]
    s_mov_b32 s96, 0xc000c000
    s_mov_b32 s97, 0xc000c000
    s_nop 1
    v_cndmask_b32 v234, v234, v206, s[96:97]
    v_cndmask_b32 v235, v235, v207, s[96:97]
    v_cndmask_b32 v236, v236, v208, s[96:97]
    v_cndmask_b32 v237, v237, v209, s[96:97]
    v_max3_f32 v238, v234, v235, v236
    v_max_f32 v238, v238, v237
    s_nop 1
    v_max_f32_dpp v238, v238, v238 quad_perm:[2,3,0,1] row_mask:0xf bank_mask:0xf
    s_nop 1
    v_max_f32_dpp v238, v238, v238 row_ror:4 row_mask:0xf bank_mask:0xf
    s_nop 1
    v_max_f32_dpp v238, v238, v238 row_ror:8 row_mask:0xf bank_mask:0xf
    v_mov_b32 v239, v238
    s_nop 1
    v_permlane16_swap_b32 v238, v239
    v_max_f32 v238, v238, v239
    v_mov_b32 v239, v238
    s_nop 1
    v_permlane32_swap_b32 v238, v239
    v_max_f32 v238, v238, v239
    v_mul_f32 v240, s86, v238
    v_mul_f32 v241, -1.0, v240
    s_mov_b64 exec, 3
    ds_write_b32 v23, v240
    s_mov_b64 exec, -1
    v_fma_f32 v234, v234, s86, v241
    v_fma_f32 v235, v235, s86, v241
    v_fma_f32 v236, v236, s86, v241
    v_fma_f32 v237, v237, s86, v241
    v_exp_f32 v234, v234
    v_exp_f32 v235, v235
    v_exp_f32 v236, v236
    v_exp_f32 v237, v237
    v_cvt_pk_bf16_f32 v174, v234, v235
    v_cvt_pk_bf16_f32 v175, v236, v237
    s_nop 0
    v_mov_b32_dpp v176, v174 row_shl:2 row_mask:0xf bank_mask:0xf bound_ctrl:0
    v_mov_b32_dpp v177, v175 row_shl:2 row_mask:0xf bank_mask:0xf bound_ctrl:0
    s_nop 1
    v_mfma_f32_16x16x32_bf16 v[202:205], a[128:131], v[174:177], 0
    v_mov_b32_dpp v178, v174 row_shl:4 row_mask:0xf bank_mask:0xf bound_ctrl:0
    v_add_f32 v234, v234, v235
    v_mfma_f32_16x16x32_bf16 v[206:209], a[132:135], v[174:177], 0
    v_mov_b32_dpp v179, v175 row_shl:4 row_mask:0xf bank_mask:0xf bound_ctrl:0
    v_add_f32 v236, v236, v237
    v_mfma_f32_16x16x32_bf16 v[210:213], a[136:139], v[174:177], 0
    v_mov_b32_dpp v180, v174 row_shl:6 row_mask:0xf bank_mask:0xf bound_ctrl:0
    v_add_f32 v234, v234, v236
    v_mfma_f32_16x16x32_bf16 v[214:217], a[140:143], v[174:177], 0
    v_mov_b32_dpp v181, v175 row_shl:6 row_mask:0xf bank_mask:0xf bound_ctrl:0
    v_add_f32_dpp v234, v234, v234 quad_perm:[2,3,0,1] row_mask:0xf bank_mask:0xf
    v_mfma_f32_16x16x32_bf16 v[218:221], a[144:147], v[174:177], 0
    v_mov_b32_dpp v182, v174 row_shl:8 row_mask:0xf bank_mask:0xf bound_ctrl:0
    v_add_f32_dpp v234, v234, v234 row_ror:4 row_mask:0xf bank_mask:0xf
    v_mfma_f32_16x16x32_bf16 v[222:225], a[148:151], v[174:177], 0
    v_mov_b32_dpp v183, v175 row_shl:8 row_mask:0xf bank_mask:0xf bound_ctrl:0
    v_add_f32_dpp v234, v234, v234 row_ror:8 row_mask:0xf bank_mask:0xf
    v_mfma_f32_16x16x32_bf16 v[226:229], a[152:155], v[174:177], 0
    v_mov_b32_dpp v184, v174 row_shl:10 row_mask:0xf bank_mask:0xf bound_ctrl:0
    v_mov_b32_dpp v185, v175 row_shl:10 row_mask:0xf bank_mask:0xf bound_ctrl:0
    v_mov_b32_dpp v186, v174 row_shl:12 row_mask:0xf bank_mask:0xf bound_ctrl:0
    v_mfma_f32_16x16x32_bf16 v[230:233], a[156:159], v[174:177], 0
    v_mov_b32_dpp v187, v175 row_shl:12 row_mask:0xf bank_mask:0xf bound_ctrl:0
    v_mov_b32_dpp v188, v174 row_shl:14 row_mask:0xf bank_mask:0xf bound_ctrl:0
    v_mov_b32_dpp v189, v175 row_shl:14 row_mask:0xf bank_mask:0xf bound_ctrl:0
    s_waitcnt lgkmcnt(0)
    s_barrier
    ds_read_b128 v[242:245], v53
    v_mfma_f32_16x16x32_bf16 v[202:205], a[160:163], v[178:181], v[202:205]
    v_mov_b32 v235, v234
    s_nop 1
    v_permlane16_swap_b32 v234, v235
    v_mfma_f32_16x16x32_bf16 v[206:209], a[164:167], v[178:181], v[206:209]
    v_add_f32 v234, v234, v235
    v_mov_b32 v235, v234
    v_mfma_f32_16x16x32_bf16 v[210:213], a[168:171], v[178:181], v[210:213]
    s_nop 0
    v_permlane32_swap_b32 v234, v235
    v_add_f32 v234, v234, v235
    v_mfma_f32_16x16x32_bf16 v[214:217], a[172:175], v[178:181], v[214:217]
    s_waitcnt lgkmcnt(0)
    v_max3_f32 v238, v242, v243, v244
    v_max_f32 v240, v238, v245
    v_mfma_f32_16x16x32_bf16 v[218:221], a[176:179], v[178:181], v[218:221]
    v_sub_f32 v42, v242, v240
    v_sub_f32 v43, v243, v240
    v_mfma_f32_16x16x32_bf16 v[222:225], a[180:183], v[178:181], v[222:225]
    v_sub_f32 v44, v244, v240
    v_sub_f32 v45, v245, v240
    v_mfma_f32_16x16x32_bf16 v[226:229], a[184:187], v[178:181], v[226:229]
    v_exp_f32 v42, v42
    v_mfma_f32_16x16x32_bf16 v[230:233], a[188:191], v[178:181], v[230:233]
    v_exp_f32 v43, v43
    v_exp_f32 v44, v44
    v_exp_f32 v45, v45
    v_mfma_f32_16x16x32_bf16 v[202:205], a[192:195], v[182:185], v[202:205]
    s_mov_b64 exec, 3
    v_mfma_f32_16x16x32_bf16 v[202:205], a[224:227], v[186:189], v[202:205]
    ds_write_b32 v23, v234 offset:32
    v_mfma_f32_16x16x32_bf16 v[206:209], a[196:199], v[182:185], v[206:209]
    s_mov_b32 exec_lo, 0x00030003
    v_mfma_f32_16x16x32_bf16 v[206:209], a[228:231], v[186:189], v[206:209]
    s_mov_b32 exec_hi, 0x00030003
    v_mfma_f32_16x16x32_bf16 v[210:213], a[200:203], v[182:185], v[210:213]
    s_nop 1
    ds_write_b128 v21, v[202:205] offset:0
    v_mfma_f32_16x16x32_bf16 v[210:213], a[232:235], v[186:189], v[210:213]
    v_mfma_f32_16x16x32_bf16 v[214:217], a[204:207], v[182:185], v[214:217]
    s_nop 0
    ds_write_b128 v21, v[206:209] offset:64
    v_mfma_f32_16x16x32_bf16 v[214:217], a[236:239], v[186:189], v[214:217]
    v_mfma_f32_16x16x32_bf16 v[218:221], a[208:211], v[182:185], v[218:221]
    s_nop 2
    ds_write_b128 v21, v[210:213] offset:128
    v_mfma_f32_16x16x32_bf16 v[218:221], a[240:243], v[186:189], v[218:221]
    v_mfma_f32_16x16x32_bf16 v[222:225], a[212:215], v[182:185], v[222:225]
    s_nop 0
    ds_write_b128 v21, v[214:217] offset:192
    v_mfma_f32_16x16x32_bf16 v[222:225], a[244:247], v[186:189], v[222:225]
    v_mfma_f32_16x16x32_bf16 v[226:229], a[216:219], v[182:185], v[226:229]
    s_nop 2
    ds_write_b128 v21, v[218:221] offset:256
    v_mfma_f32_16x16x32_bf16 v[226:229], a[248:251], v[186:189], v[226:229]
    v_mfma_f32_16x16x32_bf16 v[230:233], a[220:223], v[182:185], v[230:233]
    s_nop 0
    ds_write_b128 v21, v[222:225] offset:320
    v_mfma_f32_16x16x32_bf16 v[230:233], a[252:255], v[186:189], v[230:233]
    s_nop 3
    ds_write_b128 v21, v[226:229] offset:384
    s_nop 2
    ds_write_b128 v21, v[230:233] offset:448
    s_mov_b64 exec, -1
    s_waitcnt lgkmcnt(0)
    s_barrier
    s_cmp_gt_u32 s80, 1
    s_cbranch_scc1 Laf43
    ds_read_b64 v[242:243], v22 offset:0
    ds_read_b64 v[244:245], v22 offset:1024
    ds_read_b64 v[246:247], v22 offset:2048
    ds_read_b64 v[248:249], v22 offset:3072
    s_waitcnt lgkmcnt(2)
    v_pk_mul_f32 v[242:243], v[242:243], v[42:43] op_sel_hi:[1,0]
    v_pk_mul_f32 v[244:245], v[244:245], v[42:43] op_sel:[0,1] op_sel_hi:[1,1]
    s_waitcnt lgkmcnt(0)
    v_pk_fma_f32 v[242:243], v[246:247], v[44:45], v[242:243] op_sel_hi:[1,0,1]
    v_pk_fma_f32 v[244:245], v[248:249], v[44:45], v[244:245] op_sel:[0,1,0] op_sel_hi:[1,1,1]
    v_pk_add_f32 v[242:243], v[242:243], v[244:245]
    v_cvt_pk_bf16_f32 v242, v242, v243
    buffer_store_dword v242, v10, s[52:55], s27 offen
    buffer_store_dword v242, v10, s[56:59], s27 offen sc1
    s_branch Laf44
Laf43:
    s_cmp_lg_u32 s80, 2
    s_cbranch_scc1 Laf44
    ds_read_b128 v[242:245], v24 offset:32
    s_mov_b64 exec, 3
    buffer_store_dword v240, v13, s[52:55], s28 offen
    buffer_store_dword v240, v13, s[56:59], s28 offen sc1
    s_waitcnt lgkmcnt(0)
    v_pk_mul_f32 v[242:243], v[242:243], v[42:43]
    v_pk_fma_f32 v[242:243], v[244:245], v[44:45], v[242:243]
    v_add_f32 v242, v242, v243
    buffer_store_dword v242, v13, s[52:55], s28 offen offset:16
    buffer_store_dword v242, v13, s[56:59], s28 offen offset:16 sc1
    s_mov_b64 exec, -1
Laf44:
    s_branch LTOP2
LFIN:
LEND:
s_endpgm
.section .rodata,"a"
.p2align 6
.amdhsa_kernel interleave_layers__sliding_block_cached__dense_activation_gelu__decode_kernel
  .amdhsa_next_free_vgpr 512
  .amdhsa_next_free_sgpr 102
  .amdhsa_accum_offset 256
  .amdhsa_group_segment_fixed_size 0
  .amdhsa_kernarg_size 104
  .amdhsa_user_sgpr_count 2
  .amdhsa_user_sgpr_kernarg_segment_ptr 1
  .amdhsa_system_sgpr_workgroup_id_x 1
.end_amdhsa_kernel
```
